```python
import torch

def _softmax(x, axis=-1):
    return torch.softmax(x, dim=axis)

def _gelu(x):
    return torch.nn.functional.gelu(x, approximate='tanh')

def _silu(x):
    return torch.nn.functional.silu(x)

def _sigmoid(x):
    return torch.sigmoid(x)

def _layernorm(x, axis=-1, eps=1e-05):
    m = x.mean(dim=axis, keepdim=True)
    v = x.var(dim=axis, keepdim=True, unbiased=False)
    return (x - m) / torch.sqrt(v + eps)

def _scatter_add(tgt, idx, src, axis=0):
    return tgt.clone().index_add_(axis, idx, src)

def _segment_sum(src, seg, n):
    out = torch.zeros((n,) + src.shape[1:], dtype=src.dtype)
    return out.index_add_(0, seg, src)

def _pad(x, pw):
    flat = tuple((v for pair in reversed(pw) for v in pair))
    return torch.nn.functional.pad(x, flat)
kernel_name = 'adaLN_cond__mha_block_cached__dense_activation_silu__decode'

def setup_inputs():

    _w = lambda a: (lambda t: t.to(torch.bfloat16) if t.is_floating_point() else t)(torch.as_tensor(a))

    def _A_setup():
        B, Sq, D = (8, 1, 640)
        H, Sk, Dh = (32, 4096, 128)
        return {'x': _w((lambda *s: torch.randn(*s, dtype=torch.bfloat16) * 0.1)(B, Sq, D)), 'k_cache': _w((lambda *s: torch.randn(*s, dtype=torch.bfloat16) * 0.8)(B, H, Sk, Dh)), 'v_cache': _w((lambda *s: torch.randn(*s, dtype=torch.bfloat16) * 3.2)(B, H, Sk, Dh)), 'wq': _w((lambda *s: torch.randn(*s, dtype=torch.bfloat16) * 0.8)(D, H * Dh) * D ** (-0.5)), 'wo': _w((lambda *s: torch.randn(*s, dtype=torch.bfloat16) * 3.2)(H * Dh, D) * (H * Dh) ** (-0.5))}
    _A_in = _A_setup()

    def _B_setup():
        B, S, D, F = (8, 1, 640, 1728)
        return {'x': _w((lambda *s: torch.randn(*s, dtype=torch.bfloat16) * 0.1)(B, S, D)), 'w1': _w((lambda *s: torch.randn(*s, dtype=torch.bfloat16) * 3.2)(D, F) * D ** (-0.5)), 'w2': _w((lambda *s: torch.randn(*s, dtype=torch.bfloat16) * 3.2)(F, D) * F ** (-0.5))}
    _B_in = _B_setup()
    return {'A_x': _A_in['x'], 'A_k_cache': _A_in['k_cache'], 'A_v_cache': _A_in['v_cache'], 'A_wq': _A_in['wq'], 'A_wo': _A_in['wo'], 'B_x': _B_in['x'], 'B_w1': _B_in['w1'], 'B_w2': _B_in['w2'], 'c': _w((lambda *s: torch.randn(*s, dtype=torch.bfloat16) * 0.2)(8, 640) * 8.0), 'w_mod': _w((lambda *s: torch.randn(*s, dtype=torch.bfloat16) * 0.2)(640, 6 * 640) * 640 ** (-0.5) * 8.0)}

def reference(A_x, A_k_cache, A_v_cache, A_wq, A_wo, B_x, B_w1, B_w2, c, w_mod):

    def _A_ref(x, k_cache, v_cache, wq, wo):
        B, Sq, D = x.shape
        H, Dh = (32, 128)
        q = (lambda x, *d: x.permute(*d))((x @ wq).reshape(B, Sq, H, Dh), 0, 2, 1, 3)
        scores = torch.einsum('bhqd,bhkd->bhqk', q, k_cache) * Dh ** (-0.5)
        p = _softmax(scores, axis=-1)
        o = torch.einsum('bhqk,bhkd->bhqd', p, v_cache)
        return (lambda x, *d: x.permute(*d))(o, 0, 2, 1, 3).reshape(B, Sq, H * Dh) @ wo

    def _B_ref(x, w1, w2):
        h = torch.einsum('bsd,df->bsf', x, w1)
        h = _silu(h)
        out = torch.einsum('bsf,fd->bsd', h, w2)
        return out
    x = A_x
    mod = (_silu(c) @ w_mod).reshape(c.shape[0], 6, 1, -1)
    sa, ca, ga, sb, cb, gb = (mod[:, 0].clone(), mod[:, 1].clone(), mod[:, 2].clone(), mod[:, 3].clone(), mod[:, 4].clone(), mod[:, 5].clone())
    h = _layernorm(x, axis=-1) * (1 + ca) + sa
    x = x + ga * _A_ref(h, A_k_cache, A_v_cache, A_wq, A_wo)
    h = _layernorm(x, axis=-1) * (1 + cb) + sb
    x = x + gb * _B_ref(h, B_w1, B_w2)
    return x
```

```asm
; @launch grid=(256,1,1) block=(512,1,1) lds=155648
.amdgcn_target "amdgcn-amd-amdhsa--gfx950"
.text
.globl adaLN_cond__mha_block_cached__dense_activation_silu__decode_kernel
.p2align 8
.type adaLN_cond__mha_block_cached__dense_activation_silu__decode_kernel,@function
adaLN_cond__mha_block_cached__dense_activation_silu__decode_kernel:
  s_cmp_ge_u32 s2, 256
  s_cbranch_scc1 L_end
  s_load_dwordx16 s[16:31], s[0:1], 0
  s_load_dwordx8 s[32:39], s[0:1], 64
  s_load_dwordx2 s[40:41], s[0:1], 96
  v_and_b32 v1, 63, v0
  v_lshrrev_b32 v3, 6, v0
  v_lshlrev_b32 v2, 4, v1
  v_readfirstlane_b32 s3, v3
  s_lshr_b32 s4, s2, 5
  s_and_b32 s5, s2, 31
  s_lshr_b32 s6, s2, 2
  s_and_b32 s7, s2, 3
  v_and_b32 v8, 1, v1
  v_lshlrev_b32 v8, 4, v8
  v_mov_b32 v9, 0xffff
  v_lshlrev_b32 v8, v8, v9
  v_bfe_u32 v9, v1, 1, 2
  v_cmp_eq_u32 vcc, 0, v9
  s_nop 1
  v_cndmask_b32 v4, 0, v8, vcc
  v_cmp_eq_u32 vcc, 1, v9
  s_nop 1
  v_cndmask_b32 v5, 0, v8, vcc
  v_cmp_eq_u32 vcc, 2, v9
  s_nop 1
  v_cndmask_b32 v6, 0, v8, vcc
  v_cmp_eq_u32 vcc, 3, v9
  s_nop 1
  v_cndmask_b32 v7, 0, v8, vcc
  s_waitcnt lgkmcnt(0)
  s_lshl_b32 s8, s2, 20
  s_add_u32 s44, s18, s8
  s_addc_u32 s45, s19, 0
  s_mov_b32 s46, 1048576
  s_mov_b32 s47, 0x20000
  s_add_u32 s48, s20, s8
  s_addc_u32 s49, s21, 0
  s_mov_b32 s50, 1048576
  s_mov_b32 s51, 0x20000
  s_mov_b32 s52, s34
  s_mov_b32 s53, s35
  s_mov_b32 s54, 4915200
  s_mov_b32 s55, 0x20000
  s_mov_b32 s56, s22
  s_mov_b32 s57, s23
  s_mov_b32 s58, 5242880
  s_mov_b32 s59, 0x20000
  s_mov_b32 s60, s40
  s_mov_b32 s61, s41
  s_mov_b32 s62, 4194304
  s_mov_b32 s63, 0x20000
  s_mov_b32 s64, s38
  s_mov_b32 s65, s39
  s_mov_b32 s66, 256
  s_mov_b32 s67, 0x20000
  s_mov_b32 s68, s32
  s_mov_b32 s69, s33
  s_mov_b32 s70, 10240
  s_mov_b32 s71, 0x20000
  s_mov_b32 s72, s16
  s_mov_b32 s73, s17
  s_mov_b32 s74, 10240
  s_mov_b32 s75, 0x20000
  s_mov_b32 s76, s24
  s_mov_b32 s77, s25
  s_mov_b32 s78, 5242880
  s_mov_b32 s79, 0x20000
  s_mov_b32 s80, s28
  s_mov_b32 s81, s29
  s_mov_b32 s82, 2211840
  s_mov_b32 s83, 0x20000
  s_mov_b32 s84, s30
  s_mov_b32 s85, s31
  s_mov_b32 s86, 2211840
  s_mov_b32 s87, 0x20000
  s_mov_b32 s88, s36
  s_mov_b32 s89, s37
  s_mov_b32 s90, 10240
  s_mov_b32 s91, 0x20000
  v_and_b32 v10, 15, v1
  v_lshrrev_b32 v11, 4, v1
  s_sub_u32 s22, s3, 1
  s_lshl_b32 s22, s22, 12
  v_mov_b32 v13, 0
  v_mov_b32 v12, 84
  ds_write_b32 v13, v13 offset:8768
  ds_write_b32 v13, v12 offset:8776
  v_mov_b32 v12, 8
  ds_write_b32 v13, v12 offset:8780
  s_waitcnt lgkmcnt(0)
  s_barrier
  s_cmp_eq_u32 s3, 0
  s_cbranch_scc1 L_ctrl
  v_lshlrev_b32 v15, 13, v11
  v_lshl_add_u32 v15, v10, 4, v15
  s_lshl_b32 s10, s5, 8
  v_add_u32 v15, s10, v15
  s_sub_u32 s12, s3, 1
  s_lshl_b32 s12, s12, 15
  s_cmp_ge_u32 s2, 120
  s_cbranch_scc1 L_w_noprod1
  v_mul_u32_u24 v12, 7680, v11
  v_lshl_add_u32 v12, v10, 4, v12
  s_mul_i32 s10, s7, 160
  s_mul_i32 s11, s3, 20
  s_add_u32 s10, s10, s11
  s_mul_i32 s10, s10, 7680
  s_lshl_b32 s11, s6, 8
  s_add_u32 s10, s10, s11
  buffer_load_dwordx4 v[112:115], v12, s[52:55], s10 offen
  s_add_u32 s10, s10, 30720
  buffer_load_dwordx4 v[116:119], v12, s[52:55], s10 offen
  s_add_u32 s10, s10, 30720
  buffer_load_dwordx4 v[120:123], v12, s[52:55], s10 offen
  s_add_u32 s10, s10, 30720
  buffer_load_dwordx4 v[124:127], v12, s[52:55], s10 offen
  s_add_u32 s10, s10, 30720
  buffer_load_dwordx4 v[128:131], v12, s[52:55], s10 offen
  v_lshlrev_b32 v13, 3, v1
  v_cmp_gt_u32 vcc, 40, v1
  v_mov_b32 v14, 0x7fffffff
  s_nop 0
  v_cndmask_b32 v13, v14, v13, vcc
  s_mul_i32 s10, s3, 1280
  s_mul_i32 s11, s7, 320
  s_add_u32 s10, s10, s11
  buffer_load_dwordx2 v[132:133], v13, s[68:71], s10 offen
  s_barrier
L_w_noprod1:
  s_nop 7
  s_add_u32 s13, s22, 0
  buffer_load_dwordx4 v[16:19], v2, s[44:47], s13 offen offset:0 nt
  buffer_load_dwordx4 v[144:147], v15, s[56:59], s12 offen
  s_add_u32 s12, s12, 229376
  buffer_load_dwordx4 v[20:23], v2, s[44:47], s13 offen offset:1024 nt
  buffer_load_dwordx4 v[148:151], v15, s[56:59], s12 offen
  s_add_u32 s12, s12, 229376
  buffer_load_dwordx4 v[24:27], v2, s[44:47], s13 offen offset:2048 nt
  buffer_load_dwordx4 v[152:155], v15, s[56:59], s12 offen
  s_add_u32 s12, s12, 229376
  buffer_load_dwordx4 v[28:31], v2, s[44:47], s13 offen offset:3072 nt
  buffer_load_dwordx4 v[156:159], v15, s[56:59], s12 offen
  s_add_u32 s12, s12, 229376
  s_cmp_ge_u32 s2, 120
  s_cbranch_scc1 L_w_noprod2
  s_waitcnt vmcnt(8)
  v_lshlrev_b32 v252, 16, v132
  v_and_b32 v253, 0xffff0000, v132
  v_lshlrev_b32 v254, 16, v133
  v_and_b32 v255, 0xffff0000, v133
  v_mul_f32 v244, 0xbfb8aa3b, v252
  v_mul_f32 v245, 0xbfb8aa3b, v253
  v_mul_f32 v246, 0xbfb8aa3b, v254
  v_mul_f32 v247, 0xbfb8aa3b, v255
  v_exp_f32 v244, v244
  v_exp_f32 v245, v245
  v_exp_f32 v246, v246
  v_exp_f32 v247, v247
  v_add_f32 v244, 1.0, v244
  v_add_f32 v245, 1.0, v245
  v_add_f32 v246, 1.0, v246
  v_add_f32 v247, 1.0, v247
  v_rcp_f32 v244, v244
  v_rcp_f32 v245, v245
  v_rcp_f32 v246, v246
  v_rcp_f32 v247, v247
  v_mul_f32 v244, v244, v252
  v_mul_f32 v245, v245, v253
  v_mul_f32 v246, v246, v254
  v_mul_f32 v247, v247, v255
  v_cvt_pk_bf16_f32 v244, v244, v244
  v_cvt_pk_bf16_f32 v245, v245, v245
  v_cvt_pk_bf16_f32 v246, v246, v246
  v_cvt_pk_bf16_f32 v247, v247, v247
  s_and_b32 s10, s3, 1
  s_lshl_b32 s10, s10, 4
  s_lshr_b32 s11, s3, 1
  s_lshl_b32 s11, s11, 2
  s_add_u32 s10, s10, s11
  v_lshlrev_b32 v13, 7, v1
  v_add_u32 v13, s10, v13
  s_mov_b32 exec_lo, 0xffffffff
  s_mov_b32 exec_hi, 0xff
  ds_write_b32 v13, v244 offset:0
  ds_write_b32 v13, v245 offset:32
  ds_write_b32 v13, v246 offset:64
  ds_write_b32 v13, v247 offset:96
  s_mov_b32 exec_lo, -1
  s_mov_b32 exec_hi, -1
  s_waitcnt lgkmcnt(0)
  s_barrier
  v_mov_b32 v96, 0
  v_mov_b32 v97, 0
  v_mov_b32 v98, 0
  v_mov_b32 v99, 0
  v_mov_b32 v100, 0
  v_mov_b32 v101, 0
  v_mov_b32 v102, 0
  v_mov_b32 v103, 0
  v_mov_b32 v104, 0
  v_mov_b32 v105, 0
  v_mov_b32 v106, 0
  v_mov_b32 v107, 0
  v_mov_b32 v108, 0
  v_mov_b32 v109, 0
  v_mov_b32 v110, 0
  v_mov_b32 v111, 0
  v_bfe_u32 v13, v1, 3, 1
  v_lshl_add_u32 v13, v11, 1, v13
  v_lshlrev_b32 v13, 4, v13
  s_mul_i32 s10, s3, 640
  v_add_u32 v13, s10, v13
  ds_read_b128 v[134:137], v13 offset:0
  s_waitcnt lgkmcnt(0)
  v_and_b32 v244, v134, v4
  v_and_b32 v245, v134, v5
  v_and_b32 v246, v134, v6
  v_and_b32 v247, v134, v7
  s_nop 1
  v_mfma_f32_16x16x32_bf16 v[96:99], v[244:247], v[112:115], v[96:99]
  v_and_b32 v248, v135, v4
  v_and_b32 v249, v135, v5
  v_and_b32 v250, v135, v6
  v_and_b32 v251, v135, v7
  s_nop 1
  v_mfma_f32_16x16x32_bf16 v[100:103], v[248:251], v[112:115], v[100:103]
  v_and_b32 v244, v136, v4
  v_and_b32 v245, v136, v5
  v_and_b32 v246, v136, v6
  v_and_b32 v247, v136, v7
  s_nop 1
  v_mfma_f32_16x16x32_bf16 v[104:107], v[244:247], v[112:115], v[104:107]
  v_and_b32 v248, v137, v4
  v_and_b32 v249, v137, v5
  v_and_b32 v250, v137, v6
  v_and_b32 v251, v137, v7
  s_nop 1
  v_mfma_f32_16x16x32_bf16 v[108:111], v[248:251], v[112:115], v[108:111]
  ds_read_b128 v[134:137], v13 offset:128
  s_waitcnt lgkmcnt(0)
  v_and_b32 v244, v134, v4
  v_and_b32 v245, v134, v5
  v_and_b32 v246, v134, v6
  v_and_b32 v247, v134, v7
  s_nop 1
  v_mfma_f32_16x16x32_bf16 v[96:99], v[244:247], v[116:119], v[96:99]
  v_and_b32 v248, v135, v4
  v_and_b32 v249, v135, v5
  v_and_b32 v250, v135, v6
  v_and_b32 v251, v135, v7
  s_nop 1
  v_mfma_f32_16x16x32_bf16 v[100:103], v[248:251], v[116:119], v[100:103]
  v_and_b32 v244, v136, v4
  v_and_b32 v245, v136, v5
  v_and_b32 v246, v136, v6
  v_and_b32 v247, v136, v7
  s_nop 1
  v_mfma_f32_16x16x32_bf16 v[104:107], v[244:247], v[116:119], v[104:107]
  v_and_b32 v248, v137, v4
  v_and_b32 v249, v137, v5
  v_and_b32 v250, v137, v6
  v_and_b32 v251, v137, v7
  s_nop 1
  v_mfma_f32_16x16x32_bf16 v[108:111], v[248:251], v[116:119], v[108:111]
  ds_read_b128 v[134:137], v13 offset:256
  s_waitcnt lgkmcnt(0)
  v_and_b32 v244, v134, v4
  v_and_b32 v245, v134, v5
  v_and_b32 v246, v134, v6
  v_and_b32 v247, v134, v7
  s_nop 1
  v_mfma_f32_16x16x32_bf16 v[96:99], v[244:247], v[120:123], v[96:99]
  v_and_b32 v248, v135, v4
  v_and_b32 v249, v135, v5
  v_and_b32 v250, v135, v6
  v_and_b32 v251, v135, v7
  s_nop 1
  v_mfma_f32_16x16x32_bf16 v[100:103], v[248:251], v[120:123], v[100:103]
  v_and_b32 v244, v136, v4
  v_and_b32 v245, v136, v5
  v_and_b32 v246, v136, v6
  v_and_b32 v247, v136, v7
  s_nop 1
  v_mfma_f32_16x16x32_bf16 v[104:107], v[244:247], v[120:123], v[104:107]
  v_and_b32 v248, v137, v4
  v_and_b32 v249, v137, v5
  v_and_b32 v250, v137, v6
  v_and_b32 v251, v137, v7
  s_nop 1
  v_mfma_f32_16x16x32_bf16 v[108:111], v[248:251], v[120:123], v[108:111]
  ds_read_b128 v[134:137], v13 offset:384
  s_waitcnt lgkmcnt(0)
  v_and_b32 v244, v134, v4
  v_and_b32 v245, v134, v5
  v_and_b32 v246, v134, v6
  v_and_b32 v247, v134, v7
  s_nop 1
  v_mfma_f32_16x16x32_bf16 v[96:99], v[244:247], v[124:127], v[96:99]
  v_and_b32 v248, v135, v4
  v_and_b32 v249, v135, v5
  v_and_b32 v250, v135, v6
  v_and_b32 v251, v135, v7
  s_nop 1
  v_mfma_f32_16x16x32_bf16 v[100:103], v[248:251], v[124:127], v[100:103]
  v_and_b32 v244, v136, v4
  v_and_b32 v245, v136, v5
  v_and_b32 v246, v136, v6
  v_and_b32 v247, v136, v7
  s_nop 1
  v_mfma_f32_16x16x32_bf16 v[104:107], v[244:247], v[124:127], v[104:107]
  v_and_b32 v248, v137, v4
  v_and_b32 v249, v137, v5
  v_and_b32 v250, v137, v6
  v_and_b32 v251, v137, v7
  s_nop 1
  v_mfma_f32_16x16x32_bf16 v[108:111], v[248:251], v[124:127], v[108:111]
  ds_read_b128 v[134:137], v13 offset:512
  s_waitcnt lgkmcnt(0)
  v_and_b32 v244, v134, v4
  v_and_b32 v245, v134, v5
  v_and_b32 v246, v134, v6
  v_and_b32 v247, v134, v7
  s_nop 1
  v_mfma_f32_16x16x32_bf16 v[96:99], v[244:247], v[128:131], v[96:99]
  v_and_b32 v248, v135, v4
  v_and_b32 v249, v135, v5
  v_and_b32 v250, v135, v6
  v_and_b32 v251, v135, v7
  s_nop 1
  v_mfma_f32_16x16x32_bf16 v[100:103], v[248:251], v[128:131], v[100:103]
  v_and_b32 v244, v136, v4
  v_and_b32 v245, v136, v5
  v_and_b32 v246, v136, v6
  v_and_b32 v247, v136, v7
  s_nop 1
  v_mfma_f32_16x16x32_bf16 v[104:107], v[244:247], v[128:131], v[104:107]
  v_and_b32 v248, v137, v4
  v_and_b32 v249, v137, v5
  v_and_b32 v250, v137, v6
  v_and_b32 v251, v137, v7
  s_nop 1
  v_mfma_f32_16x16x32_bf16 v[108:111], v[248:251], v[128:131], v[108:111]
  v_lshrrev_b32 v13, 5, v1
  v_lshlrev_b32 v13, 9, v13
  v_lshl_add_u32 v13, v10, 5, v13
  v_bfe_u32 v14, v1, 4, 1
  v_lshl_add_u32 v13, v14, 4, v13
  s_lshl_b32 s10, s3, 12
  v_add_u32 v13, s10, v13
  ds_write_b128 v13, v[96:99] offset:24576
  ds_write_b128 v13, v[100:103] offset:25600
  ds_write_b128 v13, v[104:107] offset:26624
  ds_write_b128 v13, v[108:111] offset:27648
  s_waitcnt lgkmcnt(0)
  s_barrier
  v_lshlrev_b32 v13, 4, v1
  s_lshl_b32 s10, s3, 9
  v_add_u32 v13, s10, v13
  s_mov_b32 exec_lo, -1
  s_mov_b32 exec_hi, 0
  ds_read_b128 v[96:99], v13 offset:24576
  ds_read_b128 v[100:103], v13 offset:28672
  ds_read_b128 v[104:107], v13 offset:32768
  ds_read_b128 v[108:111], v13 offset:36864
  ds_read_b128 v[112:115], v13 offset:40960
  ds_read_b128 v[116:119], v13 offset:45056
  ds_read_b128 v[120:123], v13 offset:49152
  ds_read_b128 v[124:127], v13 offset:53248
  s_waitcnt lgkmcnt(0)
  v_add_f32 v96, v96, v100
  v_add_f32 v104, v104, v108
  v_add_f32 v112, v112, v116
  v_add_f32 v120, v120, v124
  v_add_f32 v97, v97, v101
  v_add_f32 v105, v105, v109
  v_add_f32 v113, v113, v117
  v_add_f32 v121, v121, v125
  v_add_f32 v98, v98, v102
  v_add_f32 v106, v106, v110
  v_add_f32 v114, v114, v118
  v_add_f32 v122, v122, v126
  v_add_f32 v99, v99, v103
  v_add_f32 v107, v107, v111
  v_add_f32 v115, v115, v119
  v_add_f32 v123, v123, v127
  v_add_f32 v96, v96, v104
  v_add_f32 v112, v112, v120
  v_add_f32 v97, v97, v105
  v_add_f32 v113, v113, v121
  v_add_f32 v98, v98, v106
  v_add_f32 v114, v114, v122
  v_add_f32 v99, v99, v107
  v_add_f32 v115, v115, v123
  v_add_f32 v96, v96, v112
  v_add_f32 v97, v97, v113
  v_add_f32 v98, v98, v114
  v_add_f32 v99, v99, v115
  v_min_u32 v96, 0xfffffffe, v96
  v_min_u32 v97, 0xfffffffe, v97
  v_min_u32 v98, 0xfffffffe, v98
  v_min_u32 v99, 0xfffffffe, v99
  v_lshlrev_b32 v13, 4, v1
  s_mul_i32 s10, s7, 122880
  s_lshl_b32 s11, s6, 9
  s_add_u32 s10, s10, s11
  s_mul_i32 s11, s3, 15360
  s_add_u32 s10, s10, s11
  buffer_store_dwordx4 v[96:99], v13, s[60:63], s10 offen sc1
  s_mov_b32 exec_lo, -1
  s_mov_b32 exec_hi, -1
  s_barrier
L_w_noprod2:
  s_nop 7
  s_waitcnt vmcnt(7)
  s_add_u32 s13, s22, 28672
  buffer_load_dwordx4 v[32:35], v2, s[44:47], s13 offen offset:0 nt
  s_waitcnt vmcnt(7)
  buffer_load_dwordx4 v[160:163], v15, s[56:59], s12 offen
  s_add_u32 s12, s12, 229376
  s_waitcnt vmcnt(7)
  buffer_load_dwordx4 v[36:39], v2, s[44:47], s13 offen offset:1024 nt
  s_waitcnt vmcnt(7)
  buffer_load_dwordx4 v[164:167], v15, s[56:59], s12 offen
  s_add_u32 s12, s12, 229376
  s_waitcnt vmcnt(7)
  buffer_load_dwordx4 v[40:43], v2, s[44:47], s13 offen offset:2048 nt
  s_waitcnt vmcnt(7)
  buffer_load_dwordx4 v[168:171], v15, s[56:59], s12 offen
  s_add_u32 s12, s12, 229376
  s_waitcnt vmcnt(7)
  buffer_load_dwordx4 v[44:47], v2, s[44:47], s13 offen offset:3072 nt
  s_waitcnt vmcnt(7)
  buffer_load_dwordx4 v[172:175], v15, s[56:59], s12 offen
  s_add_u32 s12, s12, 229376
  s_waitcnt vmcnt(7)
  s_add_u32 s13, s22, 57344
  buffer_load_dwordx4 v[48:51], v2, s[44:47], s13 offen offset:0 nt
  s_waitcnt vmcnt(7)
  buffer_load_dwordx4 v[176:179], v15, s[56:59], s12 offen
  s_add_u32 s12, s12, 229376
  s_waitcnt vmcnt(7)
  buffer_load_dwordx4 v[52:55], v2, s[44:47], s13 offen offset:1024 nt
  s_waitcnt vmcnt(7)
  buffer_load_dwordx4 v[180:183], v15, s[56:59], s12 offen
  s_add_u32 s12, s12, 229376
  s_waitcnt vmcnt(7)
  buffer_load_dwordx4 v[56:59], v2, s[44:47], s13 offen offset:2048 nt
  s_waitcnt vmcnt(7)
  buffer_load_dwordx4 v[184:187], v15, s[56:59], s12 offen
  s_add_u32 s12, s12, 229376
  s_waitcnt vmcnt(7)
  buffer_load_dwordx4 v[60:63], v2, s[44:47], s13 offen offset:3072 nt
  s_waitcnt vmcnt(7)
  buffer_load_dwordx4 v[188:191], v15, s[56:59], s12 offen
  s_add_u32 s12, s12, 229376
  s_waitcnt vmcnt(7)
  buffer_load_dwordx4 v[192:195], v15, s[56:59], s12 offen
  s_add_u32 s12, s12, 229376
  s_waitcnt vmcnt(7)
  buffer_load_dwordx4 v[196:199], v15, s[56:59], s12 offen
  s_add_u32 s12, s12, 229376
  s_waitcnt vmcnt(7)
  buffer_load_dwordx4 v[200:203], v15, s[56:59], s12 offen
  s_add_u32 s12, s12, 229376
  s_waitcnt vmcnt(7)
  buffer_load_dwordx4 v[204:207], v15, s[56:59], s12 offen
  s_add_u32 s12, s12, 229376
  s_waitcnt vmcnt(7)
  buffer_load_dwordx4 v[208:211], v15, s[56:59], s12 offen
  s_add_u32 s12, s12, 229376
  s_waitcnt vmcnt(7)
  buffer_load_dwordx4 v[212:215], v15, s[56:59], s12 offen
  s_add_u32 s12, s12, 229376
  s_waitcnt vmcnt(7)
  buffer_load_dwordx4 v[216:219], v15, s[56:59], s12 offen
  s_add_u32 s12, s12, 229376
  s_waitcnt vmcnt(7)
  buffer_load_dwordx4 v[220:223], v15, s[56:59], s12 offen
  s_add_u32 s12, s12, 229376
  s_waitcnt vmcnt(7)
  buffer_load_dwordx4 v[224:227], v15, s[56:59], s12 offen
  s_add_u32 s12, s12, 229376
  s_waitcnt vmcnt(7)
  buffer_load_dwordx4 v[228:231], v15, s[56:59], s12 offen
  s_add_u32 s12, s12, 229376
  s_waitcnt vmcnt(7)
  buffer_load_dwordx4 v[232:235], v15, s[56:59], s12 offen
  s_add_u32 s12, s12, 229376
  s_waitcnt vmcnt(7)
  s_add_u32 s13, s22, 86016
  buffer_load_dwordx4 v[64:67], v2, s[44:47], s13 offen offset:0 nt
  s_waitcnt vmcnt(7)
  buffer_load_dwordx4 v[68:71], v2, s[44:47], s13 offen offset:1024 nt
  s_waitcnt vmcnt(7)
  buffer_load_dwordx4 v[72:75], v2, s[44:47], s13 offen offset:2048 nt
  s_waitcnt vmcnt(7)
  buffer_load_dwordx4 v[76:79], v2, s[44:47], s13 offen offset:3072 nt
  s_waitcnt vmcnt(7)
  s_add_u32 s13, s22, 114688
  buffer_load_dwordx4 v[80:83], v2, s[44:47], s13 offen offset:0 nt
  s_waitcnt vmcnt(7)
  buffer_load_dwordx4 v[84:87], v2, s[44:47], s13 offen offset:1024 nt
  s_waitcnt vmcnt(7)
  buffer_load_dwordx4 v[88:91], v2, s[44:47], s13 offen offset:2048 nt
  s_waitcnt vmcnt(7)
  buffer_load_dwordx4 v[92:95], v2, s[44:47], s13 offen offset:3072 nt
  v_mov_b32 v13, 0
  s_mov_b32 s14, 5
  ds_read_b32 v12, v13 offset:8768
  s_waitcnt lgkmcnt(0)
  v_readfirstlane_b32 s10, v12
  s_nop 3
  s_cmp_lg_u32 s10, 0
  s_cbranch_scc1 L_qphase
  s_waitcnt vmcnt(7)
  s_add_u32 s13, s22, 143360
  buffer_load_dwordx4 v[96:99], v2, s[44:47], s13 offen offset:0 nt
  s_waitcnt vmcnt(7)
  buffer_load_dwordx4 v[100:103], v2, s[44:47], s13 offen offset:1024 nt
  s_waitcnt vmcnt(7)
  buffer_load_dwordx4 v[104:107], v2, s[44:47], s13 offen offset:2048 nt
  s_waitcnt vmcnt(7)
  buffer_load_dwordx4 v[108:111], v2, s[44:47], s13 offen offset:3072 nt
  s_mov_b32 s14, 6
  ds_read_b32 v12, v13 offset:8768
  s_waitcnt lgkmcnt(0)
  v_readfirstlane_b32 s10, v12
  s_nop 3
  s_cmp_lg_u32 s10, 0
  s_cbranch_scc1 L_qphase
  s_waitcnt vmcnt(7)
  s_add_u32 s13, s22, 172032
  buffer_load_dwordx4 v[112:115], v2, s[44:47], s13 offen offset:0 nt
  s_waitcnt vmcnt(7)
  buffer_load_dwordx4 v[116:119], v2, s[44:47], s13 offen offset:1024 nt
  s_waitcnt vmcnt(7)
  buffer_load_dwordx4 v[120:123], v2, s[44:47], s13 offen offset:2048 nt
  s_waitcnt vmcnt(7)
  buffer_load_dwordx4 v[124:127], v2, s[44:47], s13 offen offset:3072 nt
  s_mov_b32 s14, 7
  ds_read_b32 v12, v13 offset:8768
  s_waitcnt lgkmcnt(0)
  v_readfirstlane_b32 s10, v12
  s_nop 3
  s_cmp_lg_u32 s10, 0
  s_cbranch_scc1 L_qphase
  s_waitcnt vmcnt(7)
  s_add_u32 s13, s22, 200704
  buffer_load_dwordx4 v[128:131], v2, s[44:47], s13 offen offset:0 nt
  s_waitcnt vmcnt(7)
  buffer_load_dwordx4 v[132:135], v2, s[44:47], s13 offen offset:1024 nt
  s_waitcnt vmcnt(7)
  buffer_load_dwordx4 v[136:139], v2, s[44:47], s13 offen offset:2048 nt
  s_waitcnt vmcnt(7)
  buffer_load_dwordx4 v[140:143], v2, s[44:47], s13 offen offset:3072 nt
  s_mov_b32 s14, 8
  ds_read_b32 v12, v13 offset:8768
  s_waitcnt lgkmcnt(0)
  v_readfirstlane_b32 s10, v12
  s_nop 3
  s_cmp_lg_u32 s10, 0
  s_cbranch_scc1 L_qphase
  s_waitcnt vmcnt(7)
  s_add_u32 s13, s22, 229376
  s_add_u32 s10, s22, 110592
  s_mov_b32 m0, s10
  s_nop 0
  buffer_load_dwordx4 v2, s[44:47], s13 offen offset:0 nt lds
  s_waitcnt vmcnt(7)
  buffer_load_dwordx4 v2, s[44:47], s13 offen offset:1024 nt lds
  s_waitcnt vmcnt(7)
  buffer_load_dwordx4 v2, s[44:47], s13 offen offset:2048 nt lds
  s_waitcnt vmcnt(7)
  buffer_load_dwordx4 v2, s[44:47], s13 offen offset:3072 nt lds
  s_mov_b32 s14, 9
  ds_read_b32 v12, v13 offset:8768
  s_waitcnt lgkmcnt(0)
  v_readfirstlane_b32 s10, v12
  s_nop 3
  s_cmp_lg_u32 s10, 0
  s_cbranch_scc1 L_qphase
  s_waitcnt vmcnt(7)
  s_add_u32 s13, s22, 258048
  s_add_u32 s10, s22, 81920
  s_mov_b32 m0, s10
  s_nop 0
  buffer_load_dwordx4 v2, s[44:47], s13 offen offset:0 nt lds
  s_waitcnt vmcnt(7)
  buffer_load_dwordx4 v2, s[44:47], s13 offen offset:1024 nt lds
  s_waitcnt vmcnt(7)
  buffer_load_dwordx4 v2, s[44:47], s13 offen offset:2048 nt lds
  s_waitcnt vmcnt(7)
  buffer_load_dwordx4 v2, s[44:47], s13 offen offset:3072 nt lds
  s_mov_b32 s14, 10
  ds_read_b32 v12, v13 offset:8768
  s_waitcnt lgkmcnt(0)
  v_readfirstlane_b32 s10, v12
  s_nop 3
  s_cmp_lg_u32 s10, 0
  s_cbranch_scc1 L_qphase
  s_waitcnt vmcnt(7)
  s_add_u32 s13, s22, 286720
  s_add_u32 s10, s22, 53248
  s_mov_b32 m0, s10
  s_nop 0
  buffer_load_dwordx4 v2, s[44:47], s13 offen offset:0 nt lds
  s_waitcnt vmcnt(7)
  buffer_load_dwordx4 v2, s[44:47], s13 offen offset:1024 nt lds
  s_waitcnt vmcnt(7)
  buffer_load_dwordx4 v2, s[44:47], s13 offen offset:2048 nt lds
  s_waitcnt vmcnt(7)
  buffer_load_dwordx4 v2, s[44:47], s13 offen offset:3072 nt lds
  s_mov_b32 s14, 11
  ds_read_b32 v12, v13 offset:8768
  s_waitcnt lgkmcnt(0)
  v_readfirstlane_b32 s10, v12
  s_nop 3
  s_cmp_lg_u32 s10, 0
  s_cbranch_scc1 L_qphase
  s_waitcnt vmcnt(7)
  s_add_u32 s13, s22, 315392
  s_add_u32 s10, s22, 24576
  s_mov_b32 m0, s10
  s_nop 0
  buffer_load_dwordx4 v2, s[44:47], s13 offen offset:0 nt lds
  s_waitcnt vmcnt(7)
  buffer_load_dwordx4 v2, s[44:47], s13 offen offset:1024 nt lds
  s_waitcnt vmcnt(7)
  buffer_load_dwordx4 v2, s[44:47], s13 offen offset:2048 nt lds
  s_waitcnt vmcnt(7)
  buffer_load_dwordx4 v2, s[44:47], s13 offen offset:3072 nt lds
  s_mov_b32 s14, 12
L_qphase:
  s_nop 7
  s_barrier
  v_mov_b32 v240, 0
  v_mov_b32 v241, 0
  v_mov_b32 v242, 0
  v_mov_b32 v243, 0
  v_lshlrev_b32 v13, 2, v11
  s_sub_u32 s10, s3, 1
  s_lshl_b32 s10, s10, 4
  v_add_u32 v13, s10, v13
  s_waitcnt vmcnt(8)
  ds_read_b32 v252, v13 offset:5120
  ds_read_b32 v253, v13 offset:5232
  ds_read_b32 v254, v13 offset:5344
  ds_read_b32 v255, v13 offset:5456
  s_waitcnt lgkmcnt(0)
  v_and_b32 v244, v252, v4
  v_and_b32 v245, v252, v5
  v_and_b32 v246, v252, v6
  v_and_b32 v247, v252, v7
  s_nop 1
  v_mfma_f32_16x16x32_bf16 v[240:243], v[244:247], v[144:147], v[240:243]
  v_and_b32 v248, v253, v4
  v_and_b32 v249, v253, v5
  v_and_b32 v250, v253, v6
  v_and_b32 v251, v253, v7
  s_nop 1
  v_mfma_f32_16x16x32_bf16 v[240:243], v[248:251], v[148:151], v[240:243]
  v_and_b32 v244, v254, v4
  v_and_b32 v245, v254, v5
  v_and_b32 v246, v254, v6
  v_and_b32 v247, v254, v7
  s_nop 1
  v_mfma_f32_16x16x32_bf16 v[240:243], v[244:247], v[152:155], v[240:243]
  v_and_b32 v248, v255, v4
  v_and_b32 v249, v255, v5
  v_and_b32 v250, v255, v6
  v_and_b32 v251, v255, v7
  s_nop 1
  v_mfma_f32_16x16x32_bf16 v[240:243], v[248:251], v[156:159], v[240:243]
  ds_read_b32 v252, v13 offset:5568
  ds_read_b32 v253, v13 offset:5680
  ds_read_b32 v254, v13 offset:5792
  ds_read_b32 v255, v13 offset:5904
  s_waitcnt lgkmcnt(0)
  v_and_b32 v244, v252, v4
  v_and_b32 v245, v252, v5
  v_and_b32 v246, v252, v6
  v_and_b32 v247, v252, v7
  s_nop 1
  v_mfma_f32_16x16x32_bf16 v[240:243], v[244:247], v[160:163], v[240:243]
  v_and_b32 v248, v253, v4
  v_and_b32 v249, v253, v5
  v_and_b32 v250, v253, v6
  v_and_b32 v251, v253, v7
  s_nop 1
  v_mfma_f32_16x16x32_bf16 v[240:243], v[248:251], v[164:167], v[240:243]
  v_and_b32 v244, v254, v4
  v_and_b32 v245, v254, v5
  v_and_b32 v246, v254, v6
  v_and_b32 v247, v254, v7
  s_nop 1
  v_mfma_f32_16x16x32_bf16 v[240:243], v[244:247], v[168:171], v[240:243]
  v_and_b32 v248, v255, v4
  v_and_b32 v249, v255, v5
  v_and_b32 v250, v255, v6
  v_and_b32 v251, v255, v7
  s_nop 1
  v_mfma_f32_16x16x32_bf16 v[240:243], v[248:251], v[172:175], v[240:243]
  ds_read_b32 v252, v13 offset:6016
  ds_read_b32 v253, v13 offset:6128
  ds_read_b32 v254, v13 offset:6240
  ds_read_b32 v255, v13 offset:6352
  s_waitcnt lgkmcnt(0)
  v_and_b32 v244, v252, v4
  v_and_b32 v245, v252, v5
  v_and_b32 v246, v252, v6
  v_and_b32 v247, v252, v7
  s_nop 1
  v_mfma_f32_16x16x32_bf16 v[240:243], v[244:247], v[176:179], v[240:243]
  v_and_b32 v248, v253, v4
  v_and_b32 v249, v253, v5
  v_and_b32 v250, v253, v6
  v_and_b32 v251, v253, v7
  s_nop 1
  v_mfma_f32_16x16x32_bf16 v[240:243], v[248:251], v[180:183], v[240:243]
  v_and_b32 v244, v254, v4
  v_and_b32 v245, v254, v5
  v_and_b32 v246, v254, v6
  v_and_b32 v247, v254, v7
  s_nop 1
  v_mfma_f32_16x16x32_bf16 v[240:243], v[244:247], v[184:187], v[240:243]
  v_and_b32 v248, v255, v4
  v_and_b32 v249, v255, v5
  v_and_b32 v250, v255, v6
  v_and_b32 v251, v255, v7
  s_nop 1
  v_mfma_f32_16x16x32_bf16 v[240:243], v[248:251], v[188:191], v[240:243]
  ds_read_b32 v252, v13 offset:6464
  ds_read_b32 v253, v13 offset:6576
  ds_read_b32 v254, v13 offset:6688
  ds_read_b32 v255, v13 offset:6800
  s_waitcnt lgkmcnt(0)
  v_and_b32 v244, v252, v4
  v_and_b32 v245, v252, v5
  v_and_b32 v246, v252, v6
  v_and_b32 v247, v252, v7
  s_nop 1
  v_mfma_f32_16x16x32_bf16 v[240:243], v[244:247], v[192:195], v[240:243]
  v_and_b32 v248, v253, v4
  v_and_b32 v249, v253, v5
  v_and_b32 v250, v253, v6
  v_and_b32 v251, v253, v7
  s_nop 1
  v_mfma_f32_16x16x32_bf16 v[240:243], v[248:251], v[196:199], v[240:243]
  v_and_b32 v244, v254, v4
  v_and_b32 v245, v254, v5
  v_and_b32 v246, v254, v6
  v_and_b32 v247, v254, v7
  s_nop 1
  v_mfma_f32_16x16x32_bf16 v[240:243], v[244:247], v[200:203], v[240:243]
  v_and_b32 v248, v255, v4
  v_and_b32 v249, v255, v5
  v_and_b32 v250, v255, v6
  v_and_b32 v251, v255, v7
  s_nop 1
  v_mfma_f32_16x16x32_bf16 v[240:243], v[248:251], v[204:207], v[240:243]
  ds_read_b32 v252, v13 offset:6912
  ds_read_b32 v253, v13 offset:7024
  ds_read_b32 v254, v13 offset:7136
  ds_read_b32 v255, v13 offset:7248
  s_waitcnt lgkmcnt(0)
  v_and_b32 v244, v252, v4
  v_and_b32 v245, v252, v5
  v_and_b32 v246, v252, v6
  v_and_b32 v247, v252, v7
  s_nop 1
  v_mfma_f32_16x16x32_bf16 v[240:243], v[244:247], v[208:211], v[240:243]
  v_and_b32 v248, v253, v4
  v_and_b32 v249, v253, v5
  v_and_b32 v250, v253, v6
  v_and_b32 v251, v253, v7
  s_nop 1
  v_mfma_f32_16x16x32_bf16 v[240:243], v[248:251], v[212:215], v[240:243]
  v_and_b32 v244, v254, v4
  v_and_b32 v245, v254, v5
  v_and_b32 v246, v254, v6
  v_and_b32 v247, v254, v7
  s_nop 1
  v_mfma_f32_16x16x32_bf16 v[240:243], v[244:247], v[216:219], v[240:243]
  v_and_b32 v248, v255, v4
  v_and_b32 v249, v255, v5
  v_and_b32 v250, v255, v6
  v_and_b32 v251, v255, v7
  s_nop 1
  v_mfma_f32_16x16x32_bf16 v[240:243], v[248:251], v[220:223], v[240:243]
  ds_read_b32 v252, v13 offset:7360
  ds_read_b32 v253, v13 offset:7472
  ds_read_b32 v254, v13 offset:7584
  s_waitcnt lgkmcnt(0)
  v_and_b32 v244, v252, v4
  v_and_b32 v245, v252, v5
  v_and_b32 v246, v252, v6
  v_and_b32 v247, v252, v7
  s_nop 1
  v_mfma_f32_16x16x32_bf16 v[240:243], v[244:247], v[224:227], v[240:243]
  v_and_b32 v248, v253, v4
  v_and_b32 v249, v253, v5
  v_and_b32 v250, v253, v6
  v_and_b32 v251, v253, v7
  s_nop 1
  v_mfma_f32_16x16x32_bf16 v[240:243], v[248:251], v[228:231], v[240:243]
  v_and_b32 v244, v254, v4
  v_and_b32 v245, v254, v5
  v_and_b32 v246, v254, v6
  v_and_b32 v247, v254, v7
  s_nop 1
  v_mfma_f32_16x16x32_bf16 v[240:243], v[244:247], v[232:235], v[240:243]
  v_lshlrev_b32 v14, 5, v10
  v_lshl_add_u32 v14, v11, 4, v14
  s_lshl_b32 s10, s3, 9
  v_add_u32 v13, s10, v14
  s_mov_b32 exec_lo, -1
  s_mov_b32 exec_hi, 0
  s_nop 1
  ds_write_b128 v13, v[240:243] offset:20480
  s_mov_b32 exec_lo, -1
  s_mov_b32 exec_hi, -1
  s_waitcnt lgkmcnt(0)
  s_barrier
  s_branch L_q2
L_ctrl:
  s_nop 7
  v_mov_b32 v252, -1
  v_mov_b32 v253, -1
  v_mov_b32 v254, -1
  v_mov_b32 v255, -1
  s_cmp_ge_u32 s2, 40
  s_cbranch_scc1 L_c_noinit
  v_lshrrev_b32 v14, 5, v1
  v_mul_u32_u24 v14, 15360, v14
  v_and_b32 v15, 31, v1
  v_lshl_add_u32 v14, v15, 4, v14
  s_mul_i32 s10, s7, 122880
  s_lshl_b32 s11, s6, 9
  s_add_u32 s10, s10, s11
  buffer_store_dwordx4 v[252:255], v14, s[60:63], s10 offen sc1
  s_add_u32 s10, s10, 30720
  buffer_store_dwordx4 v[252:255], v14, s[60:63], s10 offen sc1
  s_add_u32 s10, s10, 30720
  buffer_store_dwordx4 v[252:255], v14, s[60:63], s10 offen sc1
  s_add_u32 s10, s10, 30720
  buffer_store_dwordx4 v[252:255], v14, s[60:63], s10 offen sc1
L_c_noinit:
  s_nop 7
  v_lshlrev_b32 v12, 3, v1
  v_cmp_gt_u32 vcc, 32, v1
  v_mov_b32 v14, 0x7fffffff
  v_add_u32 v13, 1024, v12
  v_cndmask_b32 v13, v14, v13, vcc
  s_mul_i32 s14, s4, 1280
  buffer_load_dwordx2 v[144:145], v12, s[72:75], s14 offen
  buffer_load_dwordx2 v[146:147], v12, s[72:75], s14 offen offset:512
  buffer_load_dwordx2 v[148:149], v13, s[72:75], s14 offen
  s_cmp_ge_u32 s2, 120
  s_cbranch_scc1 L_c_noprod
  v_mul_u32_u24 v12, 7680, v11
  v_lshl_add_u32 v12, v10, 4, v12
  s_mul_i32 s10, s7, 160
  s_mul_i32 s11, s3, 20
  s_add_u32 s10, s10, s11
  s_mul_i32 s10, s10, 7680
  s_lshl_b32 s11, s6, 8
  s_add_u32 s10, s10, s11
  buffer_load_dwordx4 v[112:115], v12, s[52:55], s10 offen
  s_add_u32 s10, s10, 30720
  buffer_load_dwordx4 v[116:119], v12, s[52:55], s10 offen
  s_add_u32 s10, s10, 30720
  buffer_load_dwordx4 v[120:123], v12, s[52:55], s10 offen
  s_add_u32 s10, s10, 30720
  buffer_load_dwordx4 v[124:127], v12, s[52:55], s10 offen
  s_add_u32 s10, s10, 30720
  buffer_load_dwordx4 v[128:131], v12, s[52:55], s10 offen
  v_lshlrev_b32 v13, 3, v1
  v_cmp_gt_u32 vcc, 40, v1
  v_mov_b32 v14, 0x7fffffff
  s_nop 0
  v_cndmask_b32 v13, v14, v13, vcc
  s_mul_i32 s10, s3, 1280
  s_mul_i32 s11, s7, 320
  s_add_u32 s10, s10, s11
  buffer_load_dwordx2 v[132:133], v13, s[68:71], s10 offen
  s_barrier
  s_cmp_ge_u32 s2, 40
  s_cbranch_scc1 L_c_noflag
  s_waitcnt vmcnt(9)
  v_mov_b32 v14, 1
  v_mov_b32 v13, 0
  s_lshl_b32 s10, s2, 2
  s_mov_b32 exec_lo, 1
  s_mov_b32 exec_hi, 0
  buffer_store_dword v14, v13, s[64:67], s10 offen sc1
  s_mov_b32 exec_lo, -1
  s_mov_b32 exec_hi, -1
L_c_noflag:
  s_nop 7
  s_waitcnt vmcnt(0)
  v_lshlrev_b32 v252, 16, v132
  v_and_b32 v253, 0xffff0000, v132
  v_lshlrev_b32 v254, 16, v133
  v_and_b32 v255, 0xffff0000, v133
  v_mul_f32 v244, 0xbfb8aa3b, v252
  v_mul_f32 v245, 0xbfb8aa3b, v253
  v_mul_f32 v246, 0xbfb8aa3b, v254
  v_mul_f32 v247, 0xbfb8aa3b, v255
  v_exp_f32 v244, v244
  v_exp_f32 v245, v245
  v_exp_f32 v246, v246
  v_exp_f32 v247, v247
  v_add_f32 v244, 1.0, v244
  v_add_f32 v245, 1.0, v245
  v_add_f32 v246, 1.0, v246
  v_add_f32 v247, 1.0, v247
  v_rcp_f32 v244, v244
  v_rcp_f32 v245, v245
  v_rcp_f32 v246, v246
  v_rcp_f32 v247, v247
  v_mul_f32 v244, v244, v252
  v_mul_f32 v245, v245, v253
  v_mul_f32 v246, v246, v254
  v_mul_f32 v247, v247, v255
  v_cvt_pk_bf16_f32 v244, v244, v244
  v_cvt_pk_bf16_f32 v245, v245, v245
  v_cvt_pk_bf16_f32 v246, v246, v246
  v_cvt_pk_bf16_f32 v247, v247, v247
  s_and_b32 s10, s3, 1
  s_lshl_b32 s10, s10, 4
  s_lshr_b32 s11, s3, 1
  s_lshl_b32 s11, s11, 2
  s_add_u32 s10, s10, s11
  v_lshlrev_b32 v13, 7, v1
  v_add_u32 v13, s10, v13
  s_mov_b32 exec_lo, 0xffffffff
  s_mov_b32 exec_hi, 0xff
  ds_write_b32 v13, v244 offset:0
  ds_write_b32 v13, v245 offset:32
  ds_write_b32 v13, v246 offset:64
  ds_write_b32 v13, v247 offset:96
  s_mov_b32 exec_lo, -1
  s_mov_b32 exec_hi, -1
  s_waitcnt lgkmcnt(0)
  s_barrier
  v_mov_b32 v96, 0
  v_mov_b32 v97, 0
  v_mov_b32 v98, 0
  v_mov_b32 v99, 0
  v_mov_b32 v100, 0
  v_mov_b32 v101, 0
  v_mov_b32 v102, 0
  v_mov_b32 v103, 0
  v_mov_b32 v104, 0
  v_mov_b32 v105, 0
  v_mov_b32 v106, 0
  v_mov_b32 v107, 0
  v_mov_b32 v108, 0
  v_mov_b32 v109, 0
  v_mov_b32 v110, 0
  v_mov_b32 v111, 0
  v_bfe_u32 v13, v1, 3, 1
  v_lshl_add_u32 v13, v11, 1, v13
  v_lshlrev_b32 v13, 4, v13
  s_mul_i32 s10, s3, 640
  v_add_u32 v13, s10, v13
  ds_read_b128 v[134:137], v13 offset:0
  s_waitcnt lgkmcnt(0)
  v_and_b32 v244, v134, v4
  v_and_b32 v245, v134, v5
  v_and_b32 v246, v134, v6
  v_and_b32 v247, v134, v7
  s_nop 1
  v_mfma_f32_16x16x32_bf16 v[96:99], v[244:247], v[112:115], v[96:99]
  v_and_b32 v248, v135, v4
  v_and_b32 v249, v135, v5
  v_and_b32 v250, v135, v6
  v_and_b32 v251, v135, v7
  s_nop 1
  v_mfma_f32_16x16x32_bf16 v[100:103], v[248:251], v[112:115], v[100:103]
  v_and_b32 v244, v136, v4
  v_and_b32 v245, v136, v5
  v_and_b32 v246, v136, v6
  v_and_b32 v247, v136, v7
  s_nop 1
  v_mfma_f32_16x16x32_bf16 v[104:107], v[244:247], v[112:115], v[104:107]
  v_and_b32 v248, v137, v4
  v_and_b32 v249, v137, v5
  v_and_b32 v250, v137, v6
  v_and_b32 v251, v137, v7
  s_nop 1
  v_mfma_f32_16x16x32_bf16 v[108:111], v[248:251], v[112:115], v[108:111]
  ds_read_b128 v[134:137], v13 offset:128
  s_waitcnt lgkmcnt(0)
  v_and_b32 v244, v134, v4
  v_and_b32 v245, v134, v5
  v_and_b32 v246, v134, v6
  v_and_b32 v247, v134, v7
  s_nop 1
  v_mfma_f32_16x16x32_bf16 v[96:99], v[244:247], v[116:119], v[96:99]
  v_and_b32 v248, v135, v4
  v_and_b32 v249, v135, v5
  v_and_b32 v250, v135, v6
  v_and_b32 v251, v135, v7
  s_nop 1
  v_mfma_f32_16x16x32_bf16 v[100:103], v[248:251], v[116:119], v[100:103]
  v_and_b32 v244, v136, v4
  v_and_b32 v245, v136, v5
  v_and_b32 v246, v136, v6
  v_and_b32 v247, v136, v7
  s_nop 1
  v_mfma_f32_16x16x32_bf16 v[104:107], v[244:247], v[116:119], v[104:107]
  v_and_b32 v248, v137, v4
  v_and_b32 v249, v137, v5
  v_and_b32 v250, v137, v6
  v_and_b32 v251, v137, v7
  s_nop 1
  v_mfma_f32_16x16x32_bf16 v[108:111], v[248:251], v[116:119], v[108:111]
  ds_read_b128 v[134:137], v13 offset:256
  s_waitcnt lgkmcnt(0)
  v_and_b32 v244, v134, v4
  v_and_b32 v245, v134, v5
  v_and_b32 v246, v134, v6
  v_and_b32 v247, v134, v7
  s_nop 1
  v_mfma_f32_16x16x32_bf16 v[96:99], v[244:247], v[120:123], v[96:99]
  v_and_b32 v248, v135, v4
  v_and_b32 v249, v135, v5
  v_and_b32 v250, v135, v6
  v_and_b32 v251, v135, v7
  s_nop 1
  v_mfma_f32_16x16x32_bf16 v[100:103], v[248:251], v[120:123], v[100:103]
  v_and_b32 v244, v136, v4
  v_and_b32 v245, v136, v5
  v_and_b32 v246, v136, v6
  v_and_b32 v247, v136, v7
  s_nop 1
  v_mfma_f32_16x16x32_bf16 v[104:107], v[244:247], v[120:123], v[104:107]
  v_and_b32 v248, v137, v4
  v_and_b32 v249, v137, v5
  v_and_b32 v250, v137, v6
  v_and_b32 v251, v137, v7
  s_nop 1
  v_mfma_f32_16x16x32_bf16 v[108:111], v[248:251], v[120:123], v[108:111]
  ds_read_b128 v[134:137], v13 offset:384
  s_waitcnt lgkmcnt(0)
  v_and_b32 v244, v134, v4
  v_and_b32 v245, v134, v5
  v_and_b32 v246, v134, v6
  v_and_b32 v247, v134, v7
  s_nop 1
  v_mfma_f32_16x16x32_bf16 v[96:99], v[244:247], v[124:127], v[96:99]
  v_and_b32 v248, v135, v4
  v_and_b32 v249, v135, v5
  v_and_b32 v250, v135, v6
  v_and_b32 v251, v135, v7
  s_nop 1
  v_mfma_f32_16x16x32_bf16 v[100:103], v[248:251], v[124:127], v[100:103]
  v_and_b32 v244, v136, v4
  v_and_b32 v245, v136, v5
  v_and_b32 v246, v136, v6
  v_and_b32 v247, v136, v7
  s_nop 1
  v_mfma_f32_16x16x32_bf16 v[104:107], v[244:247], v[124:127], v[104:107]
  v_and_b32 v248, v137, v4
  v_and_b32 v249, v137, v5
  v_and_b32 v250, v137, v6
  v_and_b32 v251, v137, v7
  s_nop 1
  v_mfma_f32_16x16x32_bf16 v[108:111], v[248:251], v[124:127], v[108:111]
  ds_read_b128 v[134:137], v13 offset:512
  s_waitcnt lgkmcnt(0)
  v_and_b32 v244, v134, v4
  v_and_b32 v245, v134, v5
  v_and_b32 v246, v134, v6
  v_and_b32 v247, v134, v7
  s_nop 1
  v_mfma_f32_16x16x32_bf16 v[96:99], v[244:247], v[128:131], v[96:99]
  v_and_b32 v248, v135, v4
  v_and_b32 v249, v135, v5
  v_and_b32 v250, v135, v6
  v_and_b32 v251, v135, v7
  s_nop 1
  v_mfma_f32_16x16x32_bf16 v[100:103], v[248:251], v[128:131], v[100:103]
  v_and_b32 v244, v136, v4
  v_and_b32 v245, v136, v5
  v_and_b32 v246, v136, v6
  v_and_b32 v247, v136, v7
  s_nop 1
  v_mfma_f32_16x16x32_bf16 v[104:107], v[244:247], v[128:131], v[104:107]
  v_and_b32 v248, v137, v4
  v_and_b32 v249, v137, v5
  v_and_b32 v250, v137, v6
  v_and_b32 v251, v137, v7
  s_nop 1
  v_mfma_f32_16x16x32_bf16 v[108:111], v[248:251], v[128:131], v[108:111]
  v_lshrrev_b32 v13, 5, v1
  v_lshlrev_b32 v13, 9, v13
  v_lshl_add_u32 v13, v10, 5, v13
  v_bfe_u32 v14, v1, 4, 1
  v_lshl_add_u32 v13, v14, 4, v13
  s_lshl_b32 s10, s3, 12
  v_add_u32 v13, s10, v13
  ds_write_b128 v13, v[96:99] offset:24576
  ds_write_b128 v13, v[100:103] offset:25600
  ds_write_b128 v13, v[104:107] offset:26624
  ds_write_b128 v13, v[108:111] offset:27648
  s_waitcnt lgkmcnt(0)
  s_barrier
  v_lshlrev_b32 v13, 4, v1
  s_lshl_b32 s10, s3, 9
  v_add_u32 v13, s10, v13
  s_mov_b32 exec_lo, -1
  s_mov_b32 exec_hi, 0
  ds_read_b128 v[96:99], v13 offset:24576
  ds_read_b128 v[100:103], v13 offset:28672
  ds_read_b128 v[104:107], v13 offset:32768
  ds_read_b128 v[108:111], v13 offset:36864
  ds_read_b128 v[112:115], v13 offset:40960
  ds_read_b128 v[116:119], v13 offset:45056
  ds_read_b128 v[120:123], v13 offset:49152
  ds_read_b128 v[124:127], v13 offset:53248
  s_waitcnt lgkmcnt(0)
  v_add_f32 v96, v96, v100
  v_add_f32 v104, v104, v108
  v_add_f32 v112, v112, v116
  v_add_f32 v120, v120, v124
  v_add_f32 v97, v97, v101
  v_add_f32 v105, v105, v109
  v_add_f32 v113, v113, v117
  v_add_f32 v121, v121, v125
  v_add_f32 v98, v98, v102
  v_add_f32 v106, v106, v110
  v_add_f32 v114, v114, v118
  v_add_f32 v122, v122, v126
  v_add_f32 v99, v99, v103
  v_add_f32 v107, v107, v111
  v_add_f32 v115, v115, v119
  v_add_f32 v123, v123, v127
  v_add_f32 v96, v96, v104
  v_add_f32 v112, v112, v120
  v_add_f32 v97, v97, v105
  v_add_f32 v113, v113, v121
  v_add_f32 v98, v98, v106
  v_add_f32 v114, v114, v122
  v_add_f32 v99, v99, v107
  v_add_f32 v115, v115, v123
  v_add_f32 v96, v96, v112
  v_add_f32 v97, v97, v113
  v_add_f32 v98, v98, v114
  v_add_f32 v99, v99, v115
  v_min_u32 v96, 0xfffffffe, v96
  v_min_u32 v97, 0xfffffffe, v97
  v_min_u32 v98, 0xfffffffe, v98
  v_min_u32 v99, 0xfffffffe, v99
  v_lshlrev_b32 v13, 4, v1
  s_mul_i32 s10, s7, 122880
  s_lshl_b32 s11, s6, 9
  s_add_u32 s10, s10, s11
  s_mul_i32 s11, s3, 15360
  s_add_u32 s10, s10, s11
  buffer_store_dwordx4 v[96:99], v13, s[60:63], s10 offen sc1
  s_mov_b32 exec_lo, -1
  s_mov_b32 exec_hi, -1
  s_barrier
L_c_noprod:
  s_nop 7
  v_mov_b32 v252, -1
  v_mov_b32 v253, -1
  v_mov_b32 v254, -1
  v_mov_b32 v255, -1
  v_lshrrev_b32 v8, 3, v1
  v_lshlrev_b32 v8, 12, v8
  v_and_b32 v9, 7, v1
  v_lshl_add_u32 v8, v9, 4, v8
  s_mul_i32 s10, s4, 81920
  s_lshl_b32 s11, s5, 7
  s_add_u32 s10, s10, s11
  s_add_u32 s15, s10, 524288
  s_add_u32 s42, s10, 1212416
  v_cmp_gt_u32 vcc, 32, v1
  v_mov_b32 v9, 0x7fffffff
  v_add_u32 v12, 0x10000, v8
  v_cndmask_b32 v12, v9, v12, vcc
  v_add_u32 v13, 0x8000, v8
  buffer_store_dwordx4 v[252:255], v8, s[60:63], s15 offen sc1
  buffer_store_dwordx4 v[252:255], v13, s[60:63], s15 offen sc1
  buffer_store_dwordx4 v[252:255], v12, s[60:63], s15 offen sc1
  buffer_store_dwordx4 v[252:255], v8, s[60:63], s42 offen sc1
  buffer_store_dwordx4 v[252:255], v13, s[60:63], s42 offen sc1
  buffer_store_dwordx4 v[252:255], v12, s[60:63], s42 offen sc1
  s_mul_i32 s10, s4, 2560
  s_lshl_b32 s11, s5, 7
  s_add_u32 s10, s10, s11
  s_add_u32 s43, s10, 1179648
  v_cmp_gt_u32 vcc, 8, v1
  v_lshlrev_b32 v13, 4, v1
  s_nop 0
  v_cndmask_b32 v13, v9, v13, vcc
  s_cmp_ge_u32 s5, 20
  s_cbranch_scc1 L_c_nox1
  buffer_store_dwordx4 v[252:255], v13, s[60:63], s43 offen sc1
L_c_nox1:
  s_nop 7
  v_mov_b32 v13, 0
  s_lshl_b32 s10, s2, 2
  s_add_u32 s10, s10, 1900544
  s_mov_b32 exec_lo, 1
  s_mov_b32 exec_hi, 0
  buffer_store_dword v13, v13, s[60:63], s10 offen sc1
  s_mov_b32 exec_lo, -1
  s_mov_b32 exec_hi, -1
  s_waitcnt vmcnt(0)
  v_lshlrev_b32 v160, 16, v144
  v_and_b32 v161, 0xffff0000, v144
  v_lshlrev_b32 v162, 16, v145
  v_and_b32 v163, 0xffff0000, v145
  v_lshlrev_b32 v164, 16, v146
  v_and_b32 v165, 0xffff0000, v146
  v_lshlrev_b32 v166, 16, v147
  v_and_b32 v167, 0xffff0000, v147
  v_lshlrev_b32 v168, 16, v148
  v_and_b32 v169, 0xffff0000, v148
  v_lshlrev_b32 v170, 16, v149
  v_and_b32 v171, 0xffff0000, v149
  v_add_f32 v176, v160, v161
  v_add_f32 v176, v176, v162
  v_add_f32 v176, v176, v163
  v_add_f32 v176, v176, v164
  v_add_f32 v176, v176, v165
  v_add_f32 v176, v176, v166
  v_add_f32 v176, v176, v167
  v_add_f32 v176, v176, v168
  v_add_f32 v176, v176, v169
  v_add_f32 v176, v176, v170
  v_add_f32 v176, v176, v171
  s_nop 1
  v_add_f32_dpp v176, v176, v176 quad_perm:[1,0,3,2] row_mask:0xf bank_mask:0xf
  s_nop 1
  v_add_f32_dpp v176, v176, v176 quad_perm:[2,3,0,1] row_mask:0xf bank_mask:0xf
  s_nop 1
  v_add_f32_dpp v176, v176, v176 row_ror:4 row_mask:0xf bank_mask:0xf
  s_nop 1
  v_add_f32_dpp v176, v176, v176 row_ror:8 row_mask:0xf bank_mask:0xf
  v_mov_b32 v177, v176
  s_nop 1
  v_permlane16_swap_b32 v176, v177
  v_add_f32 v176, v176, v177
  v_mov_b32 v177, v176
  s_nop 1
  v_permlane32_swap_b32 v176, v177
  v_add_f32 v176, v176, v177
  v_mul_f32 v178, 0x3acccccd, v176
  v_sub_f32 v180, v160, v178
  v_sub_f32 v181, v161, v178
  v_sub_f32 v182, v162, v178
  v_sub_f32 v183, v163, v178
  v_sub_f32 v184, v164, v178
  v_sub_f32 v185, v165, v178
  v_sub_f32 v186, v166, v178
  v_sub_f32 v187, v167, v178
  v_sub_f32 v188, v168, v178
  v_sub_f32 v189, v169, v178
  v_sub_f32 v190, v170, v178
  v_sub_f32 v191, v171, v178
  v_cmp_gt_u32 vcc, 32, v1
  s_nop 1
  v_cndmask_b32 v188, 0, v188, vcc
  v_cndmask_b32 v189, 0, v189, vcc
  v_cndmask_b32 v190, 0, v190, vcc
  v_cndmask_b32 v191, 0, v191, vcc
  v_mul_f32 v176, v180, v180
  v_fmac_f32 v176, v181, v181
  v_fmac_f32 v176, v182, v182
  v_fmac_f32 v176, v183, v183
  v_fmac_f32 v176, v184, v184
  v_fmac_f32 v176, v185, v185
  v_fmac_f32 v176, v186, v186
  v_fmac_f32 v176, v187, v187
  v_fmac_f32 v176, v188, v188
  v_fmac_f32 v176, v189, v189
  v_fmac_f32 v176, v190, v190
  v_fmac_f32 v176, v191, v191
  s_nop 1
  v_add_f32_dpp v176, v176, v176 quad_perm:[1,0,3,2] row_mask:0xf bank_mask:0xf
  s_nop 1
  v_add_f32_dpp v176, v176, v176 quad_perm:[2,3,0,1] row_mask:0xf bank_mask:0xf
  s_nop 1
  v_add_f32_dpp v176, v176, v176 row_ror:4 row_mask:0xf bank_mask:0xf
  s_nop 1
  v_add_f32_dpp v176, v176, v176 row_ror:8 row_mask:0xf bank_mask:0xf
  v_mov_b32 v177, v176
  s_nop 1
  v_permlane16_swap_b32 v176, v177
  v_add_f32 v176, v176, v177
  v_mov_b32 v177, v176
  s_nop 1
  v_permlane32_swap_b32 v176, v177
  v_add_f32 v176, v176, v177
  v_mul_f32 v179, 0x3acccccd, v176
  v_cvt_pk_bf16_f32 v177, v178, v179
  v_lshlrev_b32 v178, 16, v177
  v_and_b32 v179, 0xffff0000, v177
  v_add_f32 v179, 0x3727c5ac, v179
  v_cvt_pk_bf16_f32 v177, v179, v179
  v_lshlrev_b32 v179, 16, v177
  v_and_b32 v177, 0xffff0000, v177
  v_sqrt_f32 v179, v179
  s_nop 0
  v_cvt_pk_bf16_f32 v177, v179, v179
  v_lshlrev_b32 v179, 16, v177
  v_and_b32 v177, 0xffff0000, v177
  v_rcp_f32 v176, v179
  v_sub_f32 v180, v160, v178
  v_sub_f32 v181, v161, v178
  v_sub_f32 v182, v162, v178
  v_sub_f32 v183, v163, v178
  v_sub_f32 v184, v164, v178
  v_sub_f32 v185, v165, v178
  v_sub_f32 v186, v166, v178
  v_sub_f32 v187, v167, v178
  v_sub_f32 v188, v168, v178
  v_sub_f32 v189, v169, v178
  v_sub_f32 v190, v170, v178
  v_sub_f32 v191, v171, v178
  v_cvt_pk_bf16_f32 v177, v180, v181
  v_lshlrev_b32 v180, 16, v177
  v_and_b32 v181, 0xffff0000, v177
  v_cvt_pk_bf16_f32 v177, v182, v183
  v_lshlrev_b32 v182, 16, v177
  v_and_b32 v183, 0xffff0000, v177
  v_cvt_pk_bf16_f32 v177, v184, v185
  v_lshlrev_b32 v184, 16, v177
  v_and_b32 v185, 0xffff0000, v177
  v_cvt_pk_bf16_f32 v177, v186, v187
  v_lshlrev_b32 v186, 16, v177
  v_and_b32 v187, 0xffff0000, v177
  v_cvt_pk_bf16_f32 v177, v188, v189
  v_lshlrev_b32 v188, 16, v177
  v_and_b32 v189, 0xffff0000, v177
  v_cvt_pk_bf16_f32 v177, v190, v191
  v_lshlrev_b32 v190, 16, v177
  v_and_b32 v191, 0xffff0000, v177
  v_mul_f32 v160, v180, v176
  v_mul_f32 v161, v181, v176
  v_mul_f32 v162, v182, v176
  v_mul_f32 v163, v183, v176
  v_mul_f32 v164, v184, v176
  v_mul_f32 v165, v185, v176
  v_mul_f32 v166, v186, v176
  v_mul_f32 v167, v187, v176
  v_mul_f32 v168, v188, v176
  v_mul_f32 v169, v189, v176
  v_mul_f32 v170, v190, v176
  v_mul_f32 v171, v191, v176
  v_fma_f32 v180, -v160, v179, v180
  v_fma_f32 v181, -v161, v179, v181
  v_fma_f32 v182, -v162, v179, v182
  v_fma_f32 v183, -v163, v179, v183
  v_fma_f32 v184, -v164, v179, v184
  v_fma_f32 v185, -v165, v179, v185
  v_fma_f32 v186, -v166, v179, v186
  v_fma_f32 v187, -v167, v179, v187
  v_fma_f32 v188, -v168, v179, v188
  v_fma_f32 v189, -v169, v179, v189
  v_fma_f32 v190, -v170, v179, v190
  v_fma_f32 v191, -v171, v179, v191
  v_fmac_f32 v160, v180, v176
  v_fmac_f32 v161, v181, v176
  v_fmac_f32 v162, v182, v176
  v_fmac_f32 v163, v183, v176
  v_fmac_f32 v164, v184, v176
  v_fmac_f32 v165, v185, v176
  v_fmac_f32 v166, v186, v176
  v_fmac_f32 v167, v187, v176
  v_fmac_f32 v168, v188, v176
  v_fmac_f32 v169, v189, v176
  v_fmac_f32 v170, v190, v176
  v_fmac_f32 v171, v191, v176
  v_cvt_pk_bf16_f32 v177, v160, v161
  v_lshlrev_b32 v160, 16, v177
  v_and_b32 v161, 0xffff0000, v177
  v_cvt_pk_bf16_f32 v177, v162, v163
  v_lshlrev_b32 v162, 16, v177
  v_and_b32 v163, 0xffff0000, v177
  v_cvt_pk_bf16_f32 v177, v164, v165
  v_lshlrev_b32 v164, 16, v177
  v_and_b32 v165, 0xffff0000, v177
  v_cvt_pk_bf16_f32 v177, v166, v167
  v_lshlrev_b32 v166, 16, v177
  v_and_b32 v167, 0xffff0000, v177
  v_cvt_pk_bf16_f32 v177, v168, v169
  v_lshlrev_b32 v168, 16, v177
  v_and_b32 v169, 0xffff0000, v177
  v_cvt_pk_bf16_f32 v177, v170, v171
  v_lshlrev_b32 v170, 16, v177
  v_and_b32 v171, 0xffff0000, v177
  s_mov_b32 s95, 0
  v_lshlrev_b32 v12, 2, v1
  s_mov_b32 exec_lo, -1
  s_mov_b32 exec_hi, 0xff
L_poll1:
  s_nop 7
  buffer_load_dword v13, v12, s[64:67], 0 offen sc1
  s_waitcnt vmcnt(0)
  v_cmp_eq_u32 vcc, 0, v13
  s_cbranch_vccz L_poll1_done
  s_sleep 8
  s_add_u32 s95, s95, 1
  s_cmp_lt_u32 s95, 200000
  s_cbranch_scc1 L_poll1
L_poll1_done:
  s_nop 7
  s_mov_b32 exec_lo, -1
  s_mov_b32 exec_hi, -1
  v_lshlrev_b32 v12, 4, v1
  v_cmp_gt_u32 vcc, 32, v1
  v_mov_b32 v14, 0x7fffffff
  v_add_u32 v13, 2048, v12
  v_cndmask_b32 v13, v14, v13, vcc
  s_mul_i32 s10, s4, 15360
  s_mov_b32 s95, 0
L_poll3:
  s_nop 7
  s_add_u32 s11, s10, 0
  buffer_load_dwordx4 v[16:19], v12, s[60:63], s11 offen offset:0 sc1
  s_add_u32 s11, s10, 0
  buffer_load_dwordx4 v[32:35], v12, s[60:63], s11 offen offset:1024 sc1
  s_add_u32 s11, s10, 0
  buffer_load_dwordx4 v[48:51], v13, s[60:63], s11 offen offset:0 sc1
  s_add_u32 s11, s10, 2560
  buffer_load_dwordx4 v[64:67], v12, s[60:63], s11 offen offset:0 sc1
  s_add_u32 s11, s10, 2560
  buffer_load_dwordx4 v[80:83], v12, s[60:63], s11 offen offset:1024 sc1
  s_add_u32 s11, s10, 2560
  buffer_load_dwordx4 v[96:99], v13, s[60:63], s11 offen offset:0 sc1
  s_add_u32 s11, s10, 122880
  buffer_load_dwordx4 v[20:23], v12, s[60:63], s11 offen offset:0 sc1
  s_add_u32 s11, s10, 122880
  buffer_load_dwordx4 v[36:39], v12, s[60:63], s11 offen offset:1024 sc1
  s_add_u32 s11, s10, 122880
  buffer_load_dwordx4 v[52:55], v13, s[60:63], s11 offen offset:0 sc1
  s_add_u32 s11, s10, 125440
  buffer_load_dwordx4 v[68:71], v12, s[60:63], s11 offen offset:0 sc1
  s_add_u32 s11, s10, 125440
  buffer_load_dwordx4 v[84:87], v12, s[60:63], s11 offen offset:1024 sc1
  s_add_u32 s11, s10, 125440
  buffer_load_dwordx4 v[100:103], v13, s[60:63], s11 offen offset:0 sc1
  s_add_u32 s11, s10, 245760
  buffer_load_dwordx4 v[24:27], v12, s[60:63], s11 offen offset:0 sc1
  s_add_u32 s11, s10, 245760
  buffer_load_dwordx4 v[40:43], v12, s[60:63], s11 offen offset:1024 sc1
  s_add_u32 s11, s10, 245760
  buffer_load_dwordx4 v[56:59], v13, s[60:63], s11 offen offset:0 sc1
  s_add_u32 s11, s10, 248320
  buffer_load_dwordx4 v[72:75], v12, s[60:63], s11 offen offset:0 sc1
  s_add_u32 s11, s10, 248320
  buffer_load_dwordx4 v[88:91], v12, s[60:63], s11 offen offset:1024 sc1
  s_add_u32 s11, s10, 248320
  buffer_load_dwordx4 v[104:107], v13, s[60:63], s11 offen offset:0 sc1
  s_add_u32 s11, s10, 368640
  buffer_load_dwordx4 v[28:31], v12, s[60:63], s11 offen offset:0 sc1
  s_add_u32 s11, s10, 368640
  buffer_load_dwordx4 v[44:47], v12, s[60:63], s11 offen offset:1024 sc1
  s_add_u32 s11, s10, 368640
  buffer_load_dwordx4 v[60:63], v13, s[60:63], s11 offen offset:0 sc1
  s_add_u32 s11, s10, 371200
  buffer_load_dwordx4 v[76:79], v12, s[60:63], s11 offen offset:0 sc1
  s_add_u32 s11, s10, 371200
  buffer_load_dwordx4 v[92:95], v12, s[60:63], s11 offen offset:1024 sc1
  s_add_u32 s11, s10, 371200
  buffer_load_dwordx4 v[108:111], v13, s[60:63], s11 offen offset:0 sc1
  s_waitcnt vmcnt(0)
  v_max3_u32 v252, v16, v17, v18
  v_max3_u32 v253, v19, v20, v21
  v_max3_u32 v252, v252, v22, v23
  v_max3_u32 v253, v253, v24, v25
  v_max3_u32 v252, v252, v26, v27
  v_max3_u32 v253, v253, v28, v29
  v_max3_u32 v252, v252, v30, v31
  v_max3_u32 v253, v253, v32, v33
  v_max3_u32 v252, v252, v34, v35
  v_max3_u32 v253, v253, v36, v37
  v_max3_u32 v252, v252, v38, v39
  v_max3_u32 v253, v253, v40, v41
  v_max3_u32 v252, v252, v42, v43
  v_max3_u32 v253, v253, v44, v45
  v_max3_u32 v252, v252, v46, v47
  v_max3_u32 v253, v253, v48, v49
  v_max3_u32 v252, v252, v50, v51
  v_max3_u32 v253, v253, v52, v53
  v_max3_u32 v252, v252, v54, v55
  v_max3_u32 v253, v253, v56, v57
  v_max3_u32 v252, v252, v58, v59
  v_max3_u32 v253, v253, v60, v61
  v_max3_u32 v252, v252, v62, v63
  v_max3_u32 v253, v253, v64, v65
  v_max3_u32 v252, v252, v66, v67
  v_max3_u32 v253, v253, v68, v69
  v_max3_u32 v252, v252, v70, v71
  v_max3_u32 v253, v253, v72, v73
  v_max3_u32 v252, v252, v74, v75
  v_max3_u32 v253, v253, v76, v77
  v_max3_u32 v252, v252, v78, v79
  v_max3_u32 v253, v253, v80, v81
  v_max3_u32 v252, v252, v82, v83
  v_max3_u32 v253, v253, v84, v85
  v_max3_u32 v252, v252, v86, v87
  v_max3_u32 v253, v253, v88, v89
  v_max3_u32 v252, v252, v90, v91
  v_max3_u32 v253, v253, v92, v93
  v_max3_u32 v252, v252, v94, v95
  v_max3_u32 v253, v253, v96, v97
  v_max3_u32 v252, v252, v98, v99
  v_max3_u32 v253, v253, v100, v101
  v_max3_u32 v252, v252, v102, v103
  v_max3_u32 v253, v253, v104, v105
  v_max3_u32 v252, v252, v106, v107
  v_max3_u32 v253, v253, v108, v109
  v_max3_u32 v252, v252, v110, v111
  v_max_u32 v252, v252, v253
  v_cmp_eq_u32 vcc, -1, v252
  s_cbranch_vccz L_poll3_done
  s_add_u32 s95, s95, 1
  s_cmp_lt_u32 s95, 200000
  s_cbranch_scc1 L_poll3
L_poll3_done:
  s_nop 7
  v_add_f32 v16, v16, v20
  v_add_f32 v24, v24, v28
  v_add_f32 v16, v16, v24
  v_add_f32 v17, v17, v21
  v_add_f32 v25, v25, v29
  v_add_f32 v17, v17, v25
  v_add_f32 v18, v18, v22
  v_add_f32 v26, v26, v30
  v_add_f32 v18, v18, v26
  v_add_f32 v19, v19, v23
  v_add_f32 v27, v27, v31
  v_add_f32 v19, v19, v27
  v_cvt_pk_bf16_f32 v252, v16, v17
  v_lshlrev_b32 v16, 16, v252
  v_and_b32 v17, 0xffff0000, v252
  v_cvt_pk_bf16_f32 v252, v18, v19
  v_lshlrev_b32 v18, 16, v252
  v_and_b32 v19, 0xffff0000, v252
  v_add_f32 v32, v32, v36
  v_add_f32 v40, v40, v44
  v_add_f32 v32, v32, v40
  v_add_f32 v33, v33, v37
  v_add_f32 v41, v41, v45
  v_add_f32 v33, v33, v41
  v_add_f32 v34, v34, v38
  v_add_f32 v42, v42, v46
  v_add_f32 v34, v34, v42
  v_add_f32 v35, v35, v39
  v_add_f32 v43, v43, v47
  v_add_f32 v35, v35, v43
  v_cvt_pk_bf16_f32 v252, v32, v33
  v_lshlrev_b32 v32, 16, v252
  v_and_b32 v33, 0xffff0000, v252
  v_cvt_pk_bf16_f32 v252, v34, v35
  v_lshlrev_b32 v34, 16, v252
  v_and_b32 v35, 0xffff0000, v252
  v_add_f32 v48, v48, v52
  v_add_f32 v56, v56, v60
  v_add_f32 v48, v48, v56
  v_add_f32 v49, v49, v53
  v_add_f32 v57, v57, v61
  v_add_f32 v49, v49, v57
  v_add_f32 v50, v50, v54
  v_add_f32 v58, v58, v62
  v_add_f32 v50, v50, v58
  v_add_f32 v51, v51, v55
  v_add_f32 v59, v59, v63
  v_add_f32 v51, v51, v59
  v_cvt_pk_bf16_f32 v252, v48, v49
  v_lshlrev_b32 v48, 16, v252
  v_and_b32 v49, 0xffff0000, v252
  v_cvt_pk_bf16_f32 v252, v50, v51
  v_lshlrev_b32 v50, 16, v252
  v_and_b32 v51, 0xffff0000, v252
  v_add_f32 v64, v64, v68
  v_add_f32 v72, v72, v76
  v_add_f32 v64, v64, v72
  v_add_f32 v65, v65, v69
  v_add_f32 v73, v73, v77
  v_add_f32 v65, v65, v73
  v_add_f32 v66, v66, v70
  v_add_f32 v74, v74, v78
  v_add_f32 v66, v66, v74
  v_add_f32 v67, v67, v71
  v_add_f32 v75, v75, v79
  v_add_f32 v67, v67, v75
  v_cvt_pk_bf16_f32 v252, v64, v65
  v_lshlrev_b32 v64, 16, v252
  v_and_b32 v65, 0xffff0000, v252
  v_cvt_pk_bf16_f32 v252, v66, v67
  v_lshlrev_b32 v66, 16, v252
  v_and_b32 v67, 0xffff0000, v252
  v_add_f32 v80, v80, v84
  v_add_f32 v88, v88, v92
  v_add_f32 v80, v80, v88
  v_add_f32 v81, v81, v85
  v_add_f32 v89, v89, v93
  v_add_f32 v81, v81, v89
  v_add_f32 v82, v82, v86
  v_add_f32 v90, v90, v94
  v_add_f32 v82, v82, v90
  v_add_f32 v83, v83, v87
  v_add_f32 v91, v91, v95
  v_add_f32 v83, v83, v91
  v_cvt_pk_bf16_f32 v252, v80, v81
  v_lshlrev_b32 v80, 16, v252
  v_and_b32 v81, 0xffff0000, v252
  v_cvt_pk_bf16_f32 v252, v82, v83
  v_lshlrev_b32 v82, 16, v252
  v_and_b32 v83, 0xffff0000, v252
  v_add_f32 v96, v96, v100
  v_add_f32 v104, v104, v108
  v_add_f32 v96, v96, v104
  v_add_f32 v97, v97, v101
  v_add_f32 v105, v105, v109
  v_add_f32 v97, v97, v105
  v_add_f32 v98, v98, v102
  v_add_f32 v106, v106, v110
  v_add_f32 v98, v98, v106
  v_add_f32 v99, v99, v103
  v_add_f32 v107, v107, v111
  v_add_f32 v99, v99, v107
  v_cvt_pk_bf16_f32 v252, v96, v97
  v_lshlrev_b32 v96, 16, v252
  v_and_b32 v97, 0xffff0000, v252
  v_cvt_pk_bf16_f32 v252, v98, v99
  v_lshlrev_b32 v98, 16, v252
  v_and_b32 v99, 0xffff0000, v252
  v_add_f32 v64, 1.0, v64
  v_add_f32 v65, 1.0, v65
  v_add_f32 v66, 1.0, v66
  v_add_f32 v67, 1.0, v67
  v_cvt_pk_bf16_f32 v252, v64, v65
  v_lshlrev_b32 v64, 16, v252
  v_and_b32 v65, 0xffff0000, v252
  v_cvt_pk_bf16_f32 v252, v66, v67
  v_lshlrev_b32 v66, 16, v252
  v_and_b32 v67, 0xffff0000, v252
  v_mul_f32 v64, v64, v160
  v_mul_f32 v65, v65, v161
  v_mul_f32 v66, v66, v162
  v_mul_f32 v67, v67, v163
  v_cvt_pk_bf16_f32 v252, v64, v65
  v_lshlrev_b32 v64, 16, v252
  v_and_b32 v65, 0xffff0000, v252
  v_cvt_pk_bf16_f32 v252, v66, v67
  v_lshlrev_b32 v66, 16, v252
  v_and_b32 v67, 0xffff0000, v252
  v_add_f32 v64, v64, v16
  v_add_f32 v65, v65, v17
  v_add_f32 v66, v66, v18
  v_add_f32 v67, v67, v19
  v_cvt_pk_bf16_f32 v64, v64, v64
  v_cvt_pk_bf16_f32 v65, v65, v65
  v_cvt_pk_bf16_f32 v66, v66, v66
  v_cvt_pk_bf16_f32 v67, v67, v67
  ds_write_b128 v12, v[64:67] offset:5120
  v_add_f32 v80, 1.0, v80
  v_add_f32 v81, 1.0, v81
  v_add_f32 v82, 1.0, v82
  v_add_f32 v83, 1.0, v83
  v_cvt_pk_bf16_f32 v252, v80, v81
  v_lshlrev_b32 v80, 16, v252
  v_and_b32 v81, 0xffff0000, v252
  v_cvt_pk_bf16_f32 v252, v82, v83
  v_lshlrev_b32 v82, 16, v252
  v_and_b32 v83, 0xffff0000, v252
  v_mul_f32 v80, v80, v164
  v_mul_f32 v81, v81, v165
  v_mul_f32 v82, v82, v166
  v_mul_f32 v83, v83, v167
  v_cvt_pk_bf16_f32 v252, v80, v81
  v_lshlrev_b32 v80, 16, v252
  v_and_b32 v81, 0xffff0000, v252
  v_cvt_pk_bf16_f32 v252, v82, v83
  v_lshlrev_b32 v82, 16, v252
  v_and_b32 v83, 0xffff0000, v252
  v_add_f32 v80, v80, v32
  v_add_f32 v81, v81, v33
  v_add_f32 v82, v82, v34
  v_add_f32 v83, v83, v35
  v_cvt_pk_bf16_f32 v80, v80, v80
  v_cvt_pk_bf16_f32 v81, v81, v81
  v_cvt_pk_bf16_f32 v82, v82, v82
  v_cvt_pk_bf16_f32 v83, v83, v83
  ds_write_b128 v12, v[80:83] offset:6144
  v_add_f32 v96, 1.0, v96
  v_add_f32 v97, 1.0, v97
  v_add_f32 v98, 1.0, v98
  v_add_f32 v99, 1.0, v99
  v_cvt_pk_bf16_f32 v252, v96, v97
  v_lshlrev_b32 v96, 16, v252
  v_and_b32 v97, 0xffff0000, v252
  v_cvt_pk_bf16_f32 v252, v98, v99
  v_lshlrev_b32 v98, 16, v252
  v_and_b32 v99, 0xffff0000, v252
  v_mul_f32 v96, v96, v168
  v_mul_f32 v97, v97, v169
  v_mul_f32 v98, v98, v170
  v_mul_f32 v99, v99, v171
  v_cvt_pk_bf16_f32 v252, v96, v97
  v_lshlrev_b32 v96, 16, v252
  v_and_b32 v97, 0xffff0000, v252
  v_cvt_pk_bf16_f32 v252, v98, v99
  v_lshlrev_b32 v98, 16, v252
  v_and_b32 v99, 0xffff0000, v252
  v_add_f32 v96, v96, v48
  v_add_f32 v97, v97, v49
  v_add_f32 v98, v98, v50
  v_add_f32 v99, v99, v51
  v_cmp_gt_u32 vcc, 32, v1
  s_nop 1
  v_cndmask_b32 v96, 0, v96, vcc
  v_cndmask_b32 v97, 0, v97, vcc
  v_cndmask_b32 v98, 0, v98, vcc
  v_cndmask_b32 v99, 0, v99, vcc
  v_cvt_pk_bf16_f32 v96, v96, v96
  v_cvt_pk_bf16_f32 v97, v97, v97
  v_cvt_pk_bf16_f32 v98, v98, v98
  v_cvt_pk_bf16_f32 v99, v99, v99
  ds_write_b128 v12, v[96:99] offset:7168
  v_mov_b32 v15, 1
  v_mov_b32 v14, 0
  s_waitcnt lgkmcnt(0)
  ds_write_b32 v14, v15 offset:8768
  s_waitcnt lgkmcnt(0)
  s_mov_b32 s14, 12
  s_barrier
  v_mov_b32 v12, 1
  v_mov_b32 v13, 0
  s_mov_b32 exec_lo, 1
  s_mov_b32 exec_hi, 0
  buffer_atomic_add v12, v13, s[64:67], 0 offen offset:252 sc1
  s_mov_b32 exec_lo, -1
  s_mov_b32 exec_hi, -1
  v_lshlrev_b32 v14, 5, v10
  v_lshl_add_u32 v14, v11, 4, v14
  s_barrier
L_q2:
  s_nop 7
  s_cmp_ge_u32 s3, 2
  s_cbranch_scc1 L_q3
  v_lshlrev_b32 v13, 2, v0
  ds_read_b32 v245, v13 offset:20992
  ds_read_b32 v246, v13 offset:21504
  ds_read_b32 v247, v13 offset:22016
  ds_read_b32 v248, v13 offset:22528
  ds_read_b32 v249, v13 offset:23040
  ds_read_b32 v250, v13 offset:23552
  ds_read_b32 v251, v13 offset:24064
  s_waitcnt lgkmcnt(0)
  v_add_f32 v245, v245, v246
  v_add_f32 v245, v245, v247
  v_add_f32 v245, v245, v248
  v_add_f32 v245, v245, v249
  v_add_f32 v245, v245, v250
  v_add_f32 v245, v245, v251
  v_cvt_pk_bf16_f32 v245, v245, v245
  v_lshlrev_b32 v13, 1, v0
  ds_write_b16 v13, v245 offset:8192
  s_waitcnt lgkmcnt(0)
L_q3:
  s_nop 7
  s_barrier
  s_cmp_gt_u32 s14, 5
  s_cbranch_scc1 L_rest5
  s_add_u32 s13, s22, 143360
  buffer_load_dwordx4 v[96:99], v2, s[44:47], s13 offen offset:0 nt
  buffer_load_dwordx4 v[100:103], v2, s[44:47], s13 offen offset:1024 nt
  buffer_load_dwordx4 v[104:107], v2, s[44:47], s13 offen offset:2048 nt
  buffer_load_dwordx4 v[108:111], v2, s[44:47], s13 offen offset:3072 nt
L_rest5:
  s_nop 7
  s_cmp_gt_u32 s14, 6
  s_cbranch_scc1 L_rest6
  s_add_u32 s13, s22, 172032
  buffer_load_dwordx4 v[112:115], v2, s[44:47], s13 offen offset:0 nt
  buffer_load_dwordx4 v[116:119], v2, s[44:47], s13 offen offset:1024 nt
  buffer_load_dwordx4 v[120:123], v2, s[44:47], s13 offen offset:2048 nt
  buffer_load_dwordx4 v[124:127], v2, s[44:47], s13 offen offset:3072 nt
L_rest6:
  s_nop 7
  s_cmp_gt_u32 s14, 7
  s_cbranch_scc1 L_rest7
  s_add_u32 s13, s22, 200704
  buffer_load_dwordx4 v[128:131], v2, s[44:47], s13 offen offset:0 nt
  buffer_load_dwordx4 v[132:135], v2, s[44:47], s13 offen offset:1024 nt
  buffer_load_dwordx4 v[136:139], v2, s[44:47], s13 offen offset:2048 nt
  buffer_load_dwordx4 v[140:143], v2, s[44:47], s13 offen offset:3072 nt
L_rest7:
  s_nop 7
  s_cmp_gt_u32 s14, 8
  s_cbranch_scc1 L_rest8
  s_add_u32 s13, s22, 229376
  s_add_u32 s10, s22, 110592
  s_mov_b32 m0, s10
  s_nop 0
  buffer_load_dwordx4 v2, s[44:47], s13 offen offset:0 nt lds
  buffer_load_dwordx4 v2, s[44:47], s13 offen offset:1024 nt lds
  buffer_load_dwordx4 v2, s[44:47], s13 offen offset:2048 nt lds
  buffer_load_dwordx4 v2, s[44:47], s13 offen offset:3072 nt lds
L_rest8:
  s_nop 7
  s_cmp_gt_u32 s14, 9
  s_cbranch_scc1 L_rest9
  s_add_u32 s13, s22, 258048
  s_add_u32 s10, s22, 81920
  s_mov_b32 m0, s10
  s_nop 0
  buffer_load_dwordx4 v2, s[44:47], s13 offen offset:0 nt lds
  buffer_load_dwordx4 v2, s[44:47], s13 offen offset:1024 nt lds
  buffer_load_dwordx4 v2, s[44:47], s13 offen offset:2048 nt lds
  buffer_load_dwordx4 v2, s[44:47], s13 offen offset:3072 nt lds
L_rest9:
  s_nop 7
  s_cmp_gt_u32 s14, 10
  s_cbranch_scc1 L_rest10
  s_add_u32 s13, s22, 286720
  s_add_u32 s10, s22, 53248
  s_mov_b32 m0, s10
  s_nop 0
  buffer_load_dwordx4 v2, s[44:47], s13 offen offset:0 nt lds
  buffer_load_dwordx4 v2, s[44:47], s13 offen offset:1024 nt lds
  buffer_load_dwordx4 v2, s[44:47], s13 offen offset:2048 nt lds
  buffer_load_dwordx4 v2, s[44:47], s13 offen offset:3072 nt lds
L_rest10:
  s_nop 7
  s_cmp_gt_u32 s14, 11
  s_cbranch_scc1 L_rest11
  s_add_u32 s13, s22, 315392
  s_add_u32 s10, s22, 24576
  s_mov_b32 m0, s10
  s_nop 0
  buffer_load_dwordx4 v2, s[44:47], s13 offen offset:0 nt lds
  buffer_load_dwordx4 v2, s[44:47], s13 offen offset:1024 nt lds
  buffer_load_dwordx4 v2, s[44:47], s13 offen offset:2048 nt lds
  buffer_load_dwordx4 v2, s[44:47], s13 offen offset:3072 nt lds
L_rest11:
  s_nop 7
  v_lshlrev_b32 v13, 4, v10
  ds_read_b128 v[236:239], v13 offset:8192
  s_waitcnt lgkmcnt(0)
  v_mul_u32_u24 v8, 5120, v11
  v_lshl_add_u32 v8, v10, 4, v8
  v_lshrrev_b32 v9, 3, v1
  v_mul_u32_u24 v9, 34560, v9
  v_and_b32 v12, 7, v1
  v_lshl_add_u32 v9, v12, 4, v9
  v_mul_u32_u24 v12, 2560, v11
  v_lshl_add_u32 v12, v10, 4, v12
  s_lshl_b32 s10, s5, 7
  s_lshl_b32 s11, s3, 4
  s_add_u32 s10, s10, s11
  s_mul_i32 s96, s10, 1280
  s_mul_i32 s10, s3, 80
  s_mul_i32 s10, s10, 3456
  s_lshl_b32 s11, s5, 7
  s_add_u32 s97, s10, s11
  s_lshl_b32 s10, s5, 6
  s_lshl_b32 s11, s3, 3
  s_add_u32 s10, s10, s11
  s_mul_i32 s98, s10, 1280
  s_mov_b32 s34, 0x100000
  s_mov_b32 s35, 0x20000
  v_bfe_u32 v13, v1, 2, 1
  v_bfe_u32 v15, v1, 3, 1
  v_lshl_add_u32 v13, v13, 1, v15
  v_lshl_add_u32 v13, v13, 2, v11
  v_lshlrev_b32 v172, 2, v13
  v_add_u32 v172, 139264, v172
  v_bfe_u32 v13, v1, 2, 2
  v_lshl_add_u32 v13, v13, 2, v11
  v_lshlrev_b32 v173, 2, v13
  v_add_u32 v173, 139264, v173
  v_mov_b32 v174, 0
  v_mov_b32 v175, 1
  v_mov_b32 v234, 0
  s_mov_b32 s40, 8
  s_mov_b32 s43, 0
  s_cmp_eq_u32 s3, 0
  s_cbranch_scc1 L_w0pro
  s_sub_u32 s10, s3, 1
  s_add_u32 s24, s10, 0
  s_add_u32 s25, s10, 7
  s_add_u32 s26, s10, 14
  s_add_u32 s27, s10, 21
  s_add_u32 s28, s10, 28
  s_add_u32 s29, s10, 35
  s_add_u32 s30, s10, 42
  s_add_u32 s31, s10, 49
  s_mov_b32 s23, 1
  s_cmp_ge_u32 s3, 4
  s_cbranch_scc1 L_inact
  s_waitcnt vmcnt(44)
  v_dot2_f32_bf16 v244, v16, v236, 0
  v_dot2_f32_bf16 v245, v20, v236, 0
  v_dot2_f32_bf16 v246, v24, v236, 0
  v_dot2_f32_bf16 v247, v28, v236, 0
  v_dot2c_f32_bf16 v244, v17, v237
  v_dot2c_f32_bf16 v245, v21, v237
  v_dot2c_f32_bf16 v246, v25, v237
  v_dot2c_f32_bf16 v247, v29, v237
  v_dot2c_f32_bf16 v244, v18, v238
  v_dot2c_f32_bf16 v245, v22, v238
  v_dot2c_f32_bf16 v246, v26, v238
  v_dot2c_f32_bf16 v247, v30, v238
  v_dot2c_f32_bf16 v244, v19, v239
  v_dot2c_f32_bf16 v245, v23, v239
  v_dot2c_f32_bf16 v246, v27, v239
  v_dot2c_f32_bf16 v247, v31, v239
  s_lshl_b32 s39, s24, 6
  s_add_u32 s13, s96, 0
  buffer_load_dwordx4 v[16:19], v8, s[76:79], s13 offen
  s_add_u32 s13, s96, 256
  buffer_load_dwordx4 v[20:23], v8, s[76:79], s13 offen
  s_add_u32 s13, s96, 512
  buffer_load_dwordx4 v[24:27], v8, s[76:79], s13 offen
  s_add_u32 s13, s96, 768
  buffer_load_dwordx4 v[28:31], v8, s[76:79], s13 offen
  v_add_f32_dpp v248, v244, v244 row_ror:8 row_mask:0xf bank_mask:0x3
  v_add_f32_dpp v249, v246, v246 row_ror:8 row_mask:0xf bank_mask:0x3
  s_nop 0
  v_add_f32_dpp v248, v245, v245 row_ror:8 row_mask:0xf bank_mask:0xc
  v_add_f32_dpp v249, v247, v247 row_ror:8 row_mask:0xf bank_mask:0xc
  v_add_u32 v251, s39, v172
  v_add_f32_dpp v250, v248, v248 row_shl:4 row_mask:0xf bank_mask:0x5
  s_nop 1
  v_add_f32_dpp v250, v249, v249 row_shr:4 row_mask:0xf bank_mask:0xa
  s_nop 1
  v_add_f32_dpp v250, v250, v250 quad_perm:[1,0,3,2] row_mask:0xf bank_mask:0xf
  s_nop 1
  v_add_f32_dpp v250, v250, v250 quad_perm:[2,3,0,1] row_mask:0xf bank_mask:0xf
  ds_write_b32 v251, v250
  s_waitcnt vmcnt(44)
  v_dot2_f32_bf16 v244, v32, v236, 0
  v_dot2_f32_bf16 v245, v36, v236, 0
  v_dot2_f32_bf16 v246, v40, v236, 0
  v_dot2_f32_bf16 v247, v44, v236, 0
  v_dot2c_f32_bf16 v244, v33, v237
  v_dot2c_f32_bf16 v245, v37, v237
  v_dot2c_f32_bf16 v246, v41, v237
  v_dot2c_f32_bf16 v247, v45, v237
  v_dot2c_f32_bf16 v244, v34, v238
  v_dot2c_f32_bf16 v245, v38, v238
  v_dot2c_f32_bf16 v246, v42, v238
  v_dot2c_f32_bf16 v247, v46, v238
  v_dot2c_f32_bf16 v244, v35, v239
  v_dot2c_f32_bf16 v245, v39, v239
  v_dot2c_f32_bf16 v246, v43, v239
  v_dot2c_f32_bf16 v247, v47, v239
  s_lshl_b32 s39, s25, 6
  s_add_u32 s13, s96, 1024
  buffer_load_dwordx4 v[32:35], v8, s[76:79], s13 offen
  s_add_u32 s13, s96, 1280
  buffer_load_dwordx4 v[36:39], v8, s[76:79], s13 offen
  s_add_u32 s13, s96, 1536
  buffer_load_dwordx4 v[40:43], v8, s[76:79], s13 offen
  s_add_u32 s13, s96, 1792
  buffer_load_dwordx4 v[44:47], v8, s[76:79], s13 offen
  v_add_f32_dpp v248, v244, v244 row_ror:8 row_mask:0xf bank_mask:0x3
  v_add_f32_dpp v249, v246, v246 row_ror:8 row_mask:0xf bank_mask:0x3
  s_nop 0
  v_add_f32_dpp v248, v245, v245 row_ror:8 row_mask:0xf bank_mask:0xc
  v_add_f32_dpp v249, v247, v247 row_ror:8 row_mask:0xf bank_mask:0xc
  v_add_u32 v251, s39, v172
  v_add_f32_dpp v250, v248, v248 row_shl:4 row_mask:0xf bank_mask:0x5
  s_nop 1
  v_add_f32_dpp v250, v249, v249 row_shr:4 row_mask:0xf bank_mask:0xa
  s_nop 1
  v_add_f32_dpp v250, v250, v250 quad_perm:[1,0,3,2] row_mask:0xf bank_mask:0xf
  s_nop 1
  v_add_f32_dpp v250, v250, v250 quad_perm:[2,3,0,1] row_mask:0xf bank_mask:0xf
  ds_write_b32 v251, v250
  s_waitcnt vmcnt(44)
  v_dot2_f32_bf16 v244, v48, v236, 0
  v_dot2_f32_bf16 v245, v52, v236, 0
  v_dot2_f32_bf16 v246, v56, v236, 0
  v_dot2_f32_bf16 v247, v60, v236, 0
  v_dot2c_f32_bf16 v244, v49, v237
  v_dot2c_f32_bf16 v245, v53, v237
  v_dot2c_f32_bf16 v246, v57, v237
  v_dot2c_f32_bf16 v247, v61, v237
  v_dot2c_f32_bf16 v244, v50, v238
  v_dot2c_f32_bf16 v245, v54, v238
  v_dot2c_f32_bf16 v246, v58, v238
  v_dot2c_f32_bf16 v247, v62, v238
  v_dot2c_f32_bf16 v244, v51, v239
  v_dot2c_f32_bf16 v245, v55, v239
  v_dot2c_f32_bf16 v246, v59, v239
  v_dot2c_f32_bf16 v247, v63, v239
  s_lshl_b32 s39, s26, 6
  s_add_u32 s13, s96, 2048
  buffer_load_dwordx4 v[48:51], v8, s[76:79], s13 offen
  s_add_u32 s13, s96, 2304
  buffer_load_dwordx4 v[52:55], v8, s[76:79], s13 offen
  s_add_u32 s13, s96, 2560
  buffer_load_dwordx4 v[56:59], v8, s[76:79], s13 offen
  s_add_u32 s13, s96, 2816
  buffer_load_dwordx4 v[60:63], v8, s[76:79], s13 offen
  v_add_f32_dpp v248, v244, v244 row_ror:8 row_mask:0xf bank_mask:0x3
  v_add_f32_dpp v249, v246, v246 row_ror:8 row_mask:0xf bank_mask:0x3
  s_nop 0
  v_add_f32_dpp v248, v245, v245 row_ror:8 row_mask:0xf bank_mask:0xc
  v_add_f32_dpp v249, v247, v247 row_ror:8 row_mask:0xf bank_mask:0xc
  v_add_u32 v251, s39, v172
  v_add_f32_dpp v250, v248, v248 row_shl:4 row_mask:0xf bank_mask:0x5
  s_nop 1
  v_add_f32_dpp v250, v249, v249 row_shr:4 row_mask:0xf bank_mask:0xa
  s_nop 1
  v_add_f32_dpp v250, v250, v250 quad_perm:[1,0,3,2] row_mask:0xf bank_mask:0xf
  s_nop 1
  v_add_f32_dpp v250, v250, v250 quad_perm:[2,3,0,1] row_mask:0xf bank_mask:0xf
  ds_write_b32 v251, v250
  s_waitcnt vmcnt(44)
  v_dot2_f32_bf16 v244, v64, v236, 0
  v_dot2_f32_bf16 v245, v68, v236, 0
  v_dot2_f32_bf16 v246, v72, v236, 0
  v_dot2_f32_bf16 v247, v76, v236, 0
  v_dot2c_f32_bf16 v244, v65, v237
  v_dot2c_f32_bf16 v245, v69, v237
  v_dot2c_f32_bf16 v246, v73, v237
  v_dot2c_f32_bf16 v247, v77, v237
  v_dot2c_f32_bf16 v244, v66, v238
  v_dot2c_f32_bf16 v245, v70, v238
  v_dot2c_f32_bf16 v246, v74, v238
  v_dot2c_f32_bf16 v247, v78, v238
  v_dot2c_f32_bf16 v244, v67, v239
  v_dot2c_f32_bf16 v245, v71, v239
  v_dot2c_f32_bf16 v246, v75, v239
  v_dot2c_f32_bf16 v247, v79, v239
  s_lshl_b32 s39, s27, 6
  s_add_u32 s13, s96, 3072
  buffer_load_dwordx4 v[64:67], v8, s[76:79], s13 offen
  s_add_u32 s13, s96, 3328
  buffer_load_dwordx4 v[68:71], v8, s[76:79], s13 offen
  s_add_u32 s13, s96, 3584
  buffer_load_dwordx4 v[72:75], v8, s[76:79], s13 offen
  s_add_u32 s13, s96, 3840
  buffer_load_dwordx4 v[76:79], v8, s[76:79], s13 offen
  v_add_f32_dpp v248, v244, v244 row_ror:8 row_mask:0xf bank_mask:0x3
  v_add_f32_dpp v249, v246, v246 row_ror:8 row_mask:0xf bank_mask:0x3
  s_nop 0
  v_add_f32_dpp v248, v245, v245 row_ror:8 row_mask:0xf bank_mask:0xc
  v_add_f32_dpp v249, v247, v247 row_ror:8 row_mask:0xf bank_mask:0xc
  v_add_u32 v251, s39, v172
  v_add_f32_dpp v250, v248, v248 row_shl:4 row_mask:0xf bank_mask:0x5
  s_nop 1
  v_add_f32_dpp v250, v249, v249 row_shr:4 row_mask:0xf bank_mask:0xa
  s_nop 1
  v_add_f32_dpp v250, v250, v250 quad_perm:[1,0,3,2] row_mask:0xf bank_mask:0xf
  s_nop 1
  v_add_f32_dpp v250, v250, v250 quad_perm:[2,3,0,1] row_mask:0xf bank_mask:0xf
  ds_write_b32 v251, v250
  s_waitcnt vmcnt(44)
  v_dot2_f32_bf16 v244, v80, v236, 0
  v_dot2_f32_bf16 v245, v84, v236, 0
  v_dot2_f32_bf16 v246, v88, v236, 0
  v_dot2_f32_bf16 v247, v92, v236, 0
  v_dot2c_f32_bf16 v244, v81, v237
  v_dot2c_f32_bf16 v245, v85, v237
  v_dot2c_f32_bf16 v246, v89, v237
  v_dot2c_f32_bf16 v247, v93, v237
  v_dot2c_f32_bf16 v244, v82, v238
  v_dot2c_f32_bf16 v245, v86, v238
  v_dot2c_f32_bf16 v246, v90, v238
  v_dot2c_f32_bf16 v247, v94, v238
  v_dot2c_f32_bf16 v244, v83, v239
  v_dot2c_f32_bf16 v245, v87, v239
  v_dot2c_f32_bf16 v246, v91, v239
  v_dot2c_f32_bf16 v247, v95, v239
  s_lshl_b32 s39, s28, 6
  v_add_f32_dpp v248, v244, v244 row_ror:8 row_mask:0xf bank_mask:0x3
  v_add_f32_dpp v249, v246, v246 row_ror:8 row_mask:0xf bank_mask:0x3
  s_nop 0
  v_add_f32_dpp v248, v245, v245 row_ror:8 row_mask:0xf bank_mask:0xc
  v_add_f32_dpp v249, v247, v247 row_ror:8 row_mask:0xf bank_mask:0xc
  v_add_u32 v251, s39, v172
  v_add_f32_dpp v250, v248, v248 row_shl:4 row_mask:0xf bank_mask:0x5
  s_nop 1
  v_add_f32_dpp v250, v249, v249 row_shr:4 row_mask:0xf bank_mask:0xa
  s_nop 1
  v_add_f32_dpp v250, v250, v250 quad_perm:[1,0,3,2] row_mask:0xf bank_mask:0xf
  s_nop 1
  v_add_f32_dpp v250, v250, v250 quad_perm:[2,3,0,1] row_mask:0xf bank_mask:0xf
  ds_write_b32 v251, v250
  s_waitcnt vmcnt(40)
  v_dot2_f32_bf16 v244, v96, v236, 0
  v_dot2_f32_bf16 v245, v100, v236, 0
  v_dot2_f32_bf16 v246, v104, v236, 0
  v_dot2_f32_bf16 v247, v108, v236, 0
  v_dot2c_f32_bf16 v244, v97, v237
  v_dot2c_f32_bf16 v245, v101, v237
  v_dot2c_f32_bf16 v246, v105, v237
  v_dot2c_f32_bf16 v247, v109, v237
  v_dot2c_f32_bf16 v244, v98, v238
  v_dot2c_f32_bf16 v245, v102, v238
  v_dot2c_f32_bf16 v246, v106, v238
  v_dot2c_f32_bf16 v247, v110, v238
  v_dot2c_f32_bf16 v244, v99, v239
  v_dot2c_f32_bf16 v245, v103, v239
  v_dot2c_f32_bf16 v246, v107, v239
  v_dot2c_f32_bf16 v247, v111, v239
  s_lshl_b32 s39, s29, 6
  v_add_f32_dpp v248, v244, v244 row_ror:8 row_mask:0xf bank_mask:0x3
  v_add_f32_dpp v249, v246, v246 row_ror:8 row_mask:0xf bank_mask:0x3
  s_nop 0
  v_add_f32_dpp v248, v245, v245 row_ror:8 row_mask:0xf bank_mask:0xc
  v_add_f32_dpp v249, v247, v247 row_ror:8 row_mask:0xf bank_mask:0xc
  v_add_u32 v251, s39, v172
  v_add_f32_dpp v250, v248, v248 row_shl:4 row_mask:0xf bank_mask:0x5
  s_nop 1
  v_add_f32_dpp v250, v249, v249 row_shr:4 row_mask:0xf bank_mask:0xa
  s_nop 1
  v_add_f32_dpp v250, v250, v250 quad_perm:[1,0,3,2] row_mask:0xf bank_mask:0xf
  s_nop 1
  v_add_f32_dpp v250, v250, v250 quad_perm:[2,3,0,1] row_mask:0xf bank_mask:0xf
  ds_write_b32 v251, v250
  s_mov_b32 exec_lo, 1
  s_mov_b32 exec_hi, 0
  ds_add_rtn_u32 v252, v174, v175 offset:8776
  s_mov_b32 exec_lo, -1
  s_mov_b32 exec_hi, -1
  s_waitcnt vmcnt(36)
  v_dot2_f32_bf16 v244, v112, v236, 0
  v_dot2_f32_bf16 v245, v116, v236, 0
  v_dot2_f32_bf16 v246, v120, v236, 0
  v_dot2_f32_bf16 v247, v124, v236, 0
  v_dot2c_f32_bf16 v244, v113, v237
  v_dot2c_f32_bf16 v245, v117, v237
  v_dot2c_f32_bf16 v246, v121, v237
  v_dot2c_f32_bf16 v247, v125, v237
  v_dot2c_f32_bf16 v244, v114, v238
  v_dot2c_f32_bf16 v245, v118, v238
  v_dot2c_f32_bf16 v246, v122, v238
  v_dot2c_f32_bf16 v247, v126, v238
  v_dot2c_f32_bf16 v244, v115, v239
  v_dot2c_f32_bf16 v245, v119, v239
  v_dot2c_f32_bf16 v246, v123, v239
  v_dot2c_f32_bf16 v247, v127, v239
  s_waitcnt lgkmcnt(0)
  v_readfirstlane_b32 s36, v252
  s_nop 3
  s_cmp_lt_u32 s36, 0x100
  s_cselect_b64 s[32:33], s[44:45], s[48:49]
  s_and_b32 s37, s36, 0xff
  s_lshl_b32 s37, s37, 12
  s_lshl_b32 s39, s30, 6
  buffer_load_dwordx4 v[112:115], v2, s[32:35], s37 offen offset:0 nt
  buffer_load_dwordx4 v[116:119], v2, s[32:35], s37 offen offset:1024 nt
  buffer_load_dwordx4 v[120:123], v2, s[32:35], s37 offen offset:2048 nt
  buffer_load_dwordx4 v[124:127], v2, s[32:35], s37 offen offset:3072 nt
  v_add_f32_dpp v248, v244, v244 row_ror:8 row_mask:0xf bank_mask:0x3
  v_add_f32_dpp v249, v246, v246 row_ror:8 row_mask:0xf bank_mask:0x3
  s_nop 0
  v_add_f32_dpp v248, v245, v245 row_ror:8 row_mask:0xf bank_mask:0xc
  v_add_f32_dpp v249, v247, v247 row_ror:8 row_mask:0xf bank_mask:0xc
  v_add_u32 v251, s39, v172
  v_add_f32_dpp v250, v248, v248 row_shl:4 row_mask:0xf bank_mask:0x5
  s_nop 1
  v_add_f32_dpp v250, v249, v249 row_shr:4 row_mask:0xf bank_mask:0xa
  s_nop 1
  v_add_f32_dpp v250, v250, v250 quad_perm:[1,0,3,2] row_mask:0xf bank_mask:0xf
  s_nop 1
  v_add_f32_dpp v250, v250, v250 quad_perm:[2,3,0,1] row_mask:0xf bank_mask:0xf
  ds_write_b32 v251, v250
  s_mov_b32 s30, s36
  s_mov_b32 exec_lo, 1
  s_mov_b32 exec_hi, 0
  ds_add_rtn_u32 v252, v174, v175 offset:8776
  s_mov_b32 exec_lo, -1
  s_mov_b32 exec_hi, -1
  s_waitcnt vmcnt(36)
  v_dot2_f32_bf16 v244, v128, v236, 0
  v_dot2_f32_bf16 v245, v132, v236, 0
  v_dot2_f32_bf16 v246, v136, v236, 0
  v_dot2_f32_bf16 v247, v140, v236, 0
  v_dot2c_f32_bf16 v244, v129, v237
  v_dot2c_f32_bf16 v245, v133, v237
  v_dot2c_f32_bf16 v246, v137, v237
  v_dot2c_f32_bf16 v247, v141, v237
  v_dot2c_f32_bf16 v244, v130, v238
  v_dot2c_f32_bf16 v245, v134, v238
  v_dot2c_f32_bf16 v246, v138, v238
  v_dot2c_f32_bf16 v247, v142, v238
  v_dot2c_f32_bf16 v244, v131, v239
  v_dot2c_f32_bf16 v245, v135, v239
  v_dot2c_f32_bf16 v246, v139, v239
  v_dot2c_f32_bf16 v247, v143, v239
  s_waitcnt lgkmcnt(0)
  v_readfirstlane_b32 s36, v252
  s_nop 3
  s_cmp_lt_u32 s36, 0x100
  s_cselect_b64 s[32:33], s[44:45], s[48:49]
  s_and_b32 s37, s36, 0xff
  s_lshl_b32 s37, s37, 12
  s_lshl_b32 s39, s31, 6
  buffer_load_dwordx4 v[128:131], v2, s[32:35], s37 offen offset:0 nt
  buffer_load_dwordx4 v[132:135], v2, s[32:35], s37 offen offset:1024 nt
  buffer_load_dwordx4 v[136:139], v2, s[32:35], s37 offen offset:2048 nt
  buffer_load_dwordx4 v[140:143], v2, s[32:35], s37 offen offset:3072 nt
  v_add_f32_dpp v248, v244, v244 row_ror:8 row_mask:0xf bank_mask:0x3
  v_add_f32_dpp v249, v246, v246 row_ror:8 row_mask:0xf bank_mask:0x3
  s_nop 0
  v_add_f32_dpp v248, v245, v245 row_ror:8 row_mask:0xf bank_mask:0xc
  v_add_f32_dpp v249, v247, v247 row_ror:8 row_mask:0xf bank_mask:0xc
  v_add_u32 v251, s39, v172
  v_add_f32_dpp v250, v248, v248 row_shl:4 row_mask:0xf bank_mask:0x5
  s_nop 1
  v_add_f32_dpp v250, v249, v249 row_shr:4 row_mask:0xf bank_mask:0xa
  s_nop 1
  v_add_f32_dpp v250, v250, v250 quad_perm:[1,0,3,2] row_mask:0xf bank_mask:0xf
  s_nop 1
  v_add_f32_dpp v250, v250, v250 quad_perm:[2,3,0,1] row_mask:0xf bank_mask:0xf
  ds_write_b32 v251, v250
  s_mov_b32 s31, s36
  s_waitcnt vmcnt(24)
  s_add_u32 s10, s22, 110592
  v_add_u32 v13, s10, v2
  ds_read_b128 v[176:179], v13 offset:0
  ds_read_b128 v[180:183], v13 offset:1024
  ds_read_b128 v[184:187], v13 offset:2048
  ds_read_b128 v[188:191], v13 offset:3072
  s_waitcnt lgkmcnt(0)
  v_dot2_f32_bf16 v244, v176, v236, 0
  v_dot2_f32_bf16 v245, v180, v236, 0
  v_dot2_f32_bf16 v246, v184, v236, 0
  v_dot2_f32_bf16 v247, v188, v236, 0
  v_dot2c_f32_bf16 v244, v177, v237
  v_dot2c_f32_bf16 v245, v181, v237
  v_dot2c_f32_bf16 v246, v185, v237
  v_dot2c_f32_bf16 v247, v189, v237
  v_dot2c_f32_bf16 v244, v178, v238
  v_dot2c_f32_bf16 v245, v182, v238
  v_dot2c_f32_bf16 v246, v186, v238
  v_dot2c_f32_bf16 v247, v190, v238
  v_dot2c_f32_bf16 v244, v179, v239
  v_dot2c_f32_bf16 v245, v183, v239
  v_dot2c_f32_bf16 v246, v187, v239
  v_dot2c_f32_bf16 v247, v191, v239
  s_lshr_b32 s39, s22, 6
  s_add_u32 s39, s39, 3584
  v_add_f32_dpp v248, v244, v244 row_ror:8 row_mask:0xf bank_mask:0x3
  v_add_f32_dpp v249, v246, v246 row_ror:8 row_mask:0xf bank_mask:0x3
  s_nop 0
  v_add_f32_dpp v248, v245, v245 row_ror:8 row_mask:0xf bank_mask:0xc
  v_add_f32_dpp v249, v247, v247 row_ror:8 row_mask:0xf bank_mask:0xc
  v_add_u32 v251, s39, v172
  v_add_f32_dpp v250, v248, v248 row_shl:4 row_mask:0xf bank_mask:0x5
  s_nop 1
  v_add_f32_dpp v250, v249, v249 row_shr:4 row_mask:0xf bank_mask:0xa
  s_nop 1
  v_add_f32_dpp v250, v250, v250 quad_perm:[1,0,3,2] row_mask:0xf bank_mask:0xf
  s_nop 1
  v_add_f32_dpp v250, v250, v250 quad_perm:[2,3,0,1] row_mask:0xf bank_mask:0xf
  ds_write_b32 v251, v250
  s_add_u32 s10, s22, 81920
  v_add_u32 v13, s10, v2
  ds_read_b128 v[176:179], v13 offset:0
  ds_read_b128 v[180:183], v13 offset:1024
  ds_read_b128 v[184:187], v13 offset:2048
  ds_read_b128 v[188:191], v13 offset:3072
  s_waitcnt lgkmcnt(0)
  v_dot2_f32_bf16 v244, v176, v236, 0
  v_dot2_f32_bf16 v245, v180, v236, 0
  v_dot2_f32_bf16 v246, v184, v236, 0
  v_dot2_f32_bf16 v247, v188, v236, 0
  v_dot2c_f32_bf16 v244, v177, v237
  v_dot2c_f32_bf16 v245, v181, v237
  v_dot2c_f32_bf16 v246, v185, v237
  v_dot2c_f32_bf16 v247, v189, v237
  v_dot2c_f32_bf16 v244, v178, v238
  v_dot2c_f32_bf16 v245, v182, v238
  v_dot2c_f32_bf16 v246, v186, v238
  v_dot2c_f32_bf16 v247, v190, v238
  v_dot2c_f32_bf16 v244, v179, v239
  v_dot2c_f32_bf16 v245, v183, v239
  v_dot2c_f32_bf16 v246, v187, v239
  v_dot2c_f32_bf16 v247, v191, v239
  s_lshr_b32 s39, s22, 6
  s_add_u32 s39, s39, 4032
  v_add_f32_dpp v248, v244, v244 row_ror:8 row_mask:0xf bank_mask:0x3
  v_add_f32_dpp v249, v246, v246 row_ror:8 row_mask:0xf bank_mask:0x3
  s_nop 0
  v_add_f32_dpp v248, v245, v245 row_ror:8 row_mask:0xf bank_mask:0xc
  v_add_f32_dpp v249, v247, v247 row_ror:8 row_mask:0xf bank_mask:0xc
  v_add_u32 v251, s39, v172
  v_add_f32_dpp v250, v248, v248 row_shl:4 row_mask:0xf bank_mask:0x5
  s_nop 1
  v_add_f32_dpp v250, v249, v249 row_shr:4 row_mask:0xf bank_mask:0xa
  s_nop 1
  v_add_f32_dpp v250, v250, v250 quad_perm:[1,0,3,2] row_mask:0xf bank_mask:0xf
  s_nop 1
  v_add_f32_dpp v250, v250, v250 quad_perm:[2,3,0,1] row_mask:0xf bank_mask:0xf
  ds_write_b32 v251, v250
  s_add_u32 s10, s22, 53248
  v_add_u32 v13, s10, v2
  ds_read_b128 v[176:179], v13 offset:0
  ds_read_b128 v[180:183], v13 offset:1024
  ds_read_b128 v[184:187], v13 offset:2048
  ds_read_b128 v[188:191], v13 offset:3072
  s_waitcnt lgkmcnt(0)
  v_dot2_f32_bf16 v244, v176, v236, 0
  v_dot2_f32_bf16 v245, v180, v236, 0
  v_dot2_f32_bf16 v246, v184, v236, 0
  v_dot2_f32_bf16 v247, v188, v236, 0
  v_dot2c_f32_bf16 v244, v177, v237
  v_dot2c_f32_bf16 v245, v181, v237
  v_dot2c_f32_bf16 v246, v185, v237
  v_dot2c_f32_bf16 v247, v189, v237
  v_dot2c_f32_bf16 v244, v178, v238
  v_dot2c_f32_bf16 v245, v182, v238
  v_dot2c_f32_bf16 v246, v186, v238
  v_dot2c_f32_bf16 v247, v190, v238
  v_dot2c_f32_bf16 v244, v179, v239
  v_dot2c_f32_bf16 v245, v183, v239
  v_dot2c_f32_bf16 v246, v187, v239
  v_dot2c_f32_bf16 v247, v191, v239
  s_lshr_b32 s39, s22, 6
  s_add_u32 s39, s39, 4480
  v_add_f32_dpp v248, v244, v244 row_ror:8 row_mask:0xf bank_mask:0x3
  v_add_f32_dpp v249, v246, v246 row_ror:8 row_mask:0xf bank_mask:0x3
  s_nop 0
  v_add_f32_dpp v248, v245, v245 row_ror:8 row_mask:0xf bank_mask:0xc
  v_add_f32_dpp v249, v247, v247 row_ror:8 row_mask:0xf bank_mask:0xc
  v_add_u32 v251, s39, v172
  v_add_f32_dpp v250, v248, v248 row_shl:4 row_mask:0xf bank_mask:0x5
  s_nop 1
  v_add_f32_dpp v250, v249, v249 row_shr:4 row_mask:0xf bank_mask:0xa
  s_nop 1
  v_add_f32_dpp v250, v250, v250 quad_perm:[1,0,3,2] row_mask:0xf bank_mask:0xf
  s_nop 1
  v_add_f32_dpp v250, v250, v250 quad_perm:[2,3,0,1] row_mask:0xf bank_mask:0xf
  ds_write_b32 v251, v250
  s_add_u32 s10, s22, 24576
  v_add_u32 v13, s10, v2
  ds_read_b128 v[176:179], v13 offset:0
  ds_read_b128 v[180:183], v13 offset:1024
  ds_read_b128 v[184:187], v13 offset:2048
  ds_read_b128 v[188:191], v13 offset:3072
  s_waitcnt lgkmcnt(0)
  v_dot2_f32_bf16 v244, v176, v236, 0
  v_dot2_f32_bf16 v245, v180, v236, 0
  v_dot2_f32_bf16 v246, v184, v236, 0
  v_dot2_f32_bf16 v247, v188, v236, 0
  v_dot2c_f32_bf16 v244, v177, v237
  v_dot2c_f32_bf16 v245, v181, v237
  v_dot2c_f32_bf16 v246, v185, v237
  v_dot2c_f32_bf16 v247, v189, v237
  v_dot2c_f32_bf16 v244, v178, v238
  v_dot2c_f32_bf16 v245, v182, v238
  v_dot2c_f32_bf16 v246, v186, v238
  v_dot2c_f32_bf16 v247, v190, v238
  v_dot2c_f32_bf16 v244, v179, v239
  v_dot2c_f32_bf16 v245, v183, v239
  v_dot2c_f32_bf16 v246, v187, v239
  v_dot2c_f32_bf16 v247, v191, v239
  s_lshr_b32 s39, s22, 6
  s_add_u32 s39, s39, 4928
  v_add_f32_dpp v248, v244, v244 row_ror:8 row_mask:0xf bank_mask:0x3
  v_add_f32_dpp v249, v246, v246 row_ror:8 row_mask:0xf bank_mask:0x3
  s_nop 0
  v_add_f32_dpp v248, v245, v245 row_ror:8 row_mask:0xf bank_mask:0xc
  v_add_f32_dpp v249, v247, v247 row_ror:8 row_mask:0xf bank_mask:0xc
  v_add_u32 v251, s39, v172
  v_add_f32_dpp v250, v248, v248 row_shl:4 row_mask:0xf bank_mask:0x5
  s_nop 1
  v_add_f32_dpp v250, v249, v249 row_shr:4 row_mask:0xf bank_mask:0xa
  s_nop 1
  v_add_f32_dpp v250, v250, v250 quad_perm:[1,0,3,2] row_mask:0xf bank_mask:0xf
  s_nop 1
  v_add_f32_dpp v250, v250, v250 quad_perm:[2,3,0,1] row_mask:0xf bank_mask:0xf
  ds_write_b32 v251, v250
  s_branch L_kloop
L_inact:
  s_nop 7
  s_waitcnt vmcnt(44)
  v_dot2_f32_bf16 v244, v16, v236, 0
  v_dot2_f32_bf16 v245, v20, v236, 0
  v_dot2_f32_bf16 v246, v24, v236, 0
  v_dot2_f32_bf16 v247, v28, v236, 0
  v_dot2c_f32_bf16 v244, v17, v237
  v_dot2c_f32_bf16 v245, v21, v237
  v_dot2c_f32_bf16 v246, v25, v237
  v_dot2c_f32_bf16 v247, v29, v237
  v_dot2c_f32_bf16 v244, v18, v238
  v_dot2c_f32_bf16 v245, v22, v238
  v_dot2c_f32_bf16 v246, v26, v238
  v_dot2c_f32_bf16 v247, v30, v238
  v_dot2c_f32_bf16 v244, v19, v239
  v_dot2c_f32_bf16 v245, v23, v239
  v_dot2c_f32_bf16 v246, v27, v239
  v_dot2c_f32_bf16 v247, v31, v239
  s_lshl_b32 s39, s24, 6
  s_add_u32 s13, s96, 0
  buffer_load_dwordx4 v[16:19], v8, s[76:79], s13 offen
  s_add_u32 s13, s96, 256
  buffer_load_dwordx4 v[20:23], v8, s[76:79], s13 offen
  s_add_u32 s13, s96, 512
  buffer_load_dwordx4 v[24:27], v8, s[76:79], s13 offen
  s_add_u32 s13, s96, 768
  buffer_load_dwordx4 v[28:31], v8, s[76:79], s13 offen
  v_add_f32_dpp v248, v244, v244 row_ror:8 row_mask:0xf bank_mask:0x3
  v_add_f32_dpp v249, v246, v246 row_ror:8 row_mask:0xf bank_mask:0x3
  s_nop 0
  v_add_f32_dpp v248, v245, v245 row_ror:8 row_mask:0xf bank_mask:0xc
  v_add_f32_dpp v249, v247, v247 row_ror:8 row_mask:0xf bank_mask:0xc
  v_add_u32 v251, s39, v172
  v_add_f32_dpp v250, v248, v248 row_shl:4 row_mask:0xf bank_mask:0x5
  s_nop 1
  v_add_f32_dpp v250, v249, v249 row_shr:4 row_mask:0xf bank_mask:0xa
  s_nop 1
  v_add_f32_dpp v250, v250, v250 quad_perm:[1,0,3,2] row_mask:0xf bank_mask:0xf
  s_nop 1
  v_add_f32_dpp v250, v250, v250 quad_perm:[2,3,0,1] row_mask:0xf bank_mask:0xf
  ds_write_b32 v251, v250
  s_waitcnt vmcnt(44)
  v_dot2_f32_bf16 v244, v32, v236, 0
  v_dot2_f32_bf16 v245, v36, v236, 0
  v_dot2_f32_bf16 v246, v40, v236, 0
  v_dot2_f32_bf16 v247, v44, v236, 0
  v_dot2c_f32_bf16 v244, v33, v237
  v_dot2c_f32_bf16 v245, v37, v237
  v_dot2c_f32_bf16 v246, v41, v237
  v_dot2c_f32_bf16 v247, v45, v237
  v_dot2c_f32_bf16 v244, v34, v238
  v_dot2c_f32_bf16 v245, v38, v238
  v_dot2c_f32_bf16 v246, v42, v238
  v_dot2c_f32_bf16 v247, v46, v238
  v_dot2c_f32_bf16 v244, v35, v239
  v_dot2c_f32_bf16 v245, v39, v239
  v_dot2c_f32_bf16 v246, v43, v239
  v_dot2c_f32_bf16 v247, v47, v239
  s_lshl_b32 s39, s25, 6
  s_add_u32 s13, s96, 1024
  buffer_load_dwordx4 v[32:35], v8, s[76:79], s13 offen
  s_add_u32 s13, s96, 1280
  buffer_load_dwordx4 v[36:39], v8, s[76:79], s13 offen
  s_add_u32 s13, s96, 1536
  buffer_load_dwordx4 v[40:43], v8, s[76:79], s13 offen
  s_add_u32 s13, s96, 1792
  buffer_load_dwordx4 v[44:47], v8, s[76:79], s13 offen
  v_add_f32_dpp v248, v244, v244 row_ror:8 row_mask:0xf bank_mask:0x3
  v_add_f32_dpp v249, v246, v246 row_ror:8 row_mask:0xf bank_mask:0x3
  s_nop 0
  v_add_f32_dpp v248, v245, v245 row_ror:8 row_mask:0xf bank_mask:0xc
  v_add_f32_dpp v249, v247, v247 row_ror:8 row_mask:0xf bank_mask:0xc
  v_add_u32 v251, s39, v172
  v_add_f32_dpp v250, v248, v248 row_shl:4 row_mask:0xf bank_mask:0x5
  s_nop 1
  v_add_f32_dpp v250, v249, v249 row_shr:4 row_mask:0xf bank_mask:0xa
  s_nop 1
  v_add_f32_dpp v250, v250, v250 quad_perm:[1,0,3,2] row_mask:0xf bank_mask:0xf
  s_nop 1
  v_add_f32_dpp v250, v250, v250 quad_perm:[2,3,0,1] row_mask:0xf bank_mask:0xf
  ds_write_b32 v251, v250
  s_waitcnt vmcnt(44)
  v_dot2_f32_bf16 v244, v48, v236, 0
  v_dot2_f32_bf16 v245, v52, v236, 0
  v_dot2_f32_bf16 v246, v56, v236, 0
  v_dot2_f32_bf16 v247, v60, v236, 0
  v_dot2c_f32_bf16 v244, v49, v237
  v_dot2c_f32_bf16 v245, v53, v237
  v_dot2c_f32_bf16 v246, v57, v237
  v_dot2c_f32_bf16 v247, v61, v237
  v_dot2c_f32_bf16 v244, v50, v238
  v_dot2c_f32_bf16 v245, v54, v238
  v_dot2c_f32_bf16 v246, v58, v238
  v_dot2c_f32_bf16 v247, v62, v238
  v_dot2c_f32_bf16 v244, v51, v239
  v_dot2c_f32_bf16 v245, v55, v239
  v_dot2c_f32_bf16 v246, v59, v239
  v_dot2c_f32_bf16 v247, v63, v239
  s_lshl_b32 s39, s26, 6
  s_add_u32 s13, s96, 2048
  buffer_load_dwordx4 v[48:51], v8, s[76:79], s13 offen
  s_add_u32 s13, s96, 2304
  buffer_load_dwordx4 v[52:55], v8, s[76:79], s13 offen
  s_add_u32 s13, s96, 2560
  buffer_load_dwordx4 v[56:59], v8, s[76:79], s13 offen
  s_add_u32 s13, s96, 2816
  buffer_load_dwordx4 v[60:63], v8, s[76:79], s13 offen
  v_add_f32_dpp v248, v244, v244 row_ror:8 row_mask:0xf bank_mask:0x3
  v_add_f32_dpp v249, v246, v246 row_ror:8 row_mask:0xf bank_mask:0x3
  s_nop 0
  v_add_f32_dpp v248, v245, v245 row_ror:8 row_mask:0xf bank_mask:0xc
  v_add_f32_dpp v249, v247, v247 row_ror:8 row_mask:0xf bank_mask:0xc
  v_add_u32 v251, s39, v172
  v_add_f32_dpp v250, v248, v248 row_shl:4 row_mask:0xf bank_mask:0x5
  s_nop 1
  v_add_f32_dpp v250, v249, v249 row_shr:4 row_mask:0xf bank_mask:0xa
  s_nop 1
  v_add_f32_dpp v250, v250, v250 quad_perm:[1,0,3,2] row_mask:0xf bank_mask:0xf
  s_nop 1
  v_add_f32_dpp v250, v250, v250 quad_perm:[2,3,0,1] row_mask:0xf bank_mask:0xf
  ds_write_b32 v251, v250
  s_waitcnt vmcnt(44)
  v_dot2_f32_bf16 v244, v64, v236, 0
  v_dot2_f32_bf16 v245, v68, v236, 0
  v_dot2_f32_bf16 v246, v72, v236, 0
  v_dot2_f32_bf16 v247, v76, v236, 0
  v_dot2c_f32_bf16 v244, v65, v237
  v_dot2c_f32_bf16 v245, v69, v237
  v_dot2c_f32_bf16 v246, v73, v237
  v_dot2c_f32_bf16 v247, v77, v237
  v_dot2c_f32_bf16 v244, v66, v238
  v_dot2c_f32_bf16 v245, v70, v238
  v_dot2c_f32_bf16 v246, v74, v238
  v_dot2c_f32_bf16 v247, v78, v238
  v_dot2c_f32_bf16 v244, v67, v239
  v_dot2c_f32_bf16 v245, v71, v239
  v_dot2c_f32_bf16 v246, v75, v239
  v_dot2c_f32_bf16 v247, v79, v239
  s_lshl_b32 s39, s27, 6
  s_add_u32 s13, s96, 3072
  buffer_load_dwordx4 v[64:67], v8, s[76:79], s13 offen
  s_add_u32 s13, s96, 3328
  buffer_load_dwordx4 v[68:71], v8, s[76:79], s13 offen
  s_add_u32 s13, s96, 3584
  buffer_load_dwordx4 v[72:75], v8, s[76:79], s13 offen
  s_add_u32 s13, s96, 3840
  buffer_load_dwordx4 v[76:79], v8, s[76:79], s13 offen
  v_add_f32_dpp v248, v244, v244 row_ror:8 row_mask:0xf bank_mask:0x3
  v_add_f32_dpp v249, v246, v246 row_ror:8 row_mask:0xf bank_mask:0x3
  s_nop 0
  v_add_f32_dpp v248, v245, v245 row_ror:8 row_mask:0xf bank_mask:0xc
  v_add_f32_dpp v249, v247, v247 row_ror:8 row_mask:0xf bank_mask:0xc
  v_add_u32 v251, s39, v172
  v_add_f32_dpp v250, v248, v248 row_shl:4 row_mask:0xf bank_mask:0x5
  s_nop 1
  v_add_f32_dpp v250, v249, v249 row_shr:4 row_mask:0xf bank_mask:0xa
  s_nop 1
  v_add_f32_dpp v250, v250, v250 quad_perm:[1,0,3,2] row_mask:0xf bank_mask:0xf
  s_nop 1
  v_add_f32_dpp v250, v250, v250 quad_perm:[2,3,0,1] row_mask:0xf bank_mask:0xf
  ds_write_b32 v251, v250
  s_waitcnt vmcnt(44)
  v_dot2_f32_bf16 v244, v80, v236, 0
  v_dot2_f32_bf16 v245, v84, v236, 0
  v_dot2_f32_bf16 v246, v88, v236, 0
  v_dot2_f32_bf16 v247, v92, v236, 0
  v_dot2c_f32_bf16 v244, v81, v237
  v_dot2c_f32_bf16 v245, v85, v237
  v_dot2c_f32_bf16 v246, v89, v237
  v_dot2c_f32_bf16 v247, v93, v237
  v_dot2c_f32_bf16 v244, v82, v238
  v_dot2c_f32_bf16 v245, v86, v238
  v_dot2c_f32_bf16 v246, v90, v238
  v_dot2c_f32_bf16 v247, v94, v238
  v_dot2c_f32_bf16 v244, v83, v239
  v_dot2c_f32_bf16 v245, v87, v239
  v_dot2c_f32_bf16 v246, v91, v239
  v_dot2c_f32_bf16 v247, v95, v239
  s_lshl_b32 s39, s28, 6
  s_add_u32 s13, s96, 4096
  buffer_load_dwordx4 v[80:83], v8, s[76:79], s13 offen
  s_add_u32 s13, s96, 4352
  buffer_load_dwordx4 v[84:87], v8, s[76:79], s13 offen
  s_add_u32 s13, s96, 4608
  buffer_load_dwordx4 v[88:91], v8, s[76:79], s13 offen
  s_add_u32 s13, s96, 4864
  buffer_load_dwordx4 v[92:95], v8, s[76:79], s13 offen
  v_add_f32_dpp v248, v244, v244 row_ror:8 row_mask:0xf bank_mask:0x3
  v_add_f32_dpp v249, v246, v246 row_ror:8 row_mask:0xf bank_mask:0x3
  s_nop 0
  v_add_f32_dpp v248, v245, v245 row_ror:8 row_mask:0xf bank_mask:0xc
  v_add_f32_dpp v249, v247, v247 row_ror:8 row_mask:0xf bank_mask:0xc
  v_add_u32 v251, s39, v172
  v_add_f32_dpp v250, v248, v248 row_shl:4 row_mask:0xf bank_mask:0x5
  s_nop 1
  v_add_f32_dpp v250, v249, v249 row_shr:4 row_mask:0xf bank_mask:0xa
  s_nop 1
  v_add_f32_dpp v250, v250, v250 quad_perm:[1,0,3,2] row_mask:0xf bank_mask:0xf
  s_nop 1
  v_add_f32_dpp v250, v250, v250 quad_perm:[2,3,0,1] row_mask:0xf bank_mask:0xf
  ds_write_b32 v251, v250
  s_waitcnt vmcnt(44)
  v_dot2_f32_bf16 v244, v96, v236, 0
  v_dot2_f32_bf16 v245, v100, v236, 0
  v_dot2_f32_bf16 v246, v104, v236, 0
  v_dot2_f32_bf16 v247, v108, v236, 0
  v_dot2c_f32_bf16 v244, v97, v237
  v_dot2c_f32_bf16 v245, v101, v237
  v_dot2c_f32_bf16 v246, v105, v237
  v_dot2c_f32_bf16 v247, v109, v237
  v_dot2c_f32_bf16 v244, v98, v238
  v_dot2c_f32_bf16 v245, v102, v238
  v_dot2c_f32_bf16 v246, v106, v238
  v_dot2c_f32_bf16 v247, v110, v238
  v_dot2c_f32_bf16 v244, v99, v239
  v_dot2c_f32_bf16 v245, v103, v239
  v_dot2c_f32_bf16 v246, v107, v239
  v_dot2c_f32_bf16 v247, v111, v239
  s_lshl_b32 s39, s29, 6
  s_add_u32 s13, s97, 0
  buffer_load_dwordx4 v[96:99], v9, s[80:83], s13 offen
  s_add_u32 s13, s97, 3456
  buffer_load_dwordx4 v[100:103], v9, s[80:83], s13 offen
  s_add_u32 s13, s97, 6912
  buffer_load_dwordx4 v[104:107], v9, s[80:83], s13 offen
  s_add_u32 s13, s97, 10368
  buffer_load_dwordx4 v[108:111], v9, s[80:83], s13 offen
  v_add_f32_dpp v248, v244, v244 row_ror:8 row_mask:0xf bank_mask:0x3
  v_add_f32_dpp v249, v246, v246 row_ror:8 row_mask:0xf bank_mask:0x3
  s_nop 0
  v_add_f32_dpp v248, v245, v245 row_ror:8 row_mask:0xf bank_mask:0xc
  v_add_f32_dpp v249, v247, v247 row_ror:8 row_mask:0xf bank_mask:0xc
  v_add_u32 v251, s39, v172
  v_add_f32_dpp v250, v248, v248 row_shl:4 row_mask:0xf bank_mask:0x5
  s_nop 1
  v_add_f32_dpp v250, v249, v249 row_shr:4 row_mask:0xf bank_mask:0xa
  s_nop 1
  v_add_f32_dpp v250, v250, v250 quad_perm:[1,0,3,2] row_mask:0xf bank_mask:0xf
  s_nop 1
  v_add_f32_dpp v250, v250, v250 quad_perm:[2,3,0,1] row_mask:0xf bank_mask:0xf
  ds_write_b32 v251, v250
  s_waitcnt vmcnt(44)
  v_dot2_f32_bf16 v244, v112, v236, 0
  v_dot2_f32_bf16 v245, v116, v236, 0
  v_dot2_f32_bf16 v246, v120, v236, 0
  v_dot2_f32_bf16 v247, v124, v236, 0
  v_dot2c_f32_bf16 v244, v113, v237
  v_dot2c_f32_bf16 v245, v117, v237
  v_dot2c_f32_bf16 v246, v121, v237
  v_dot2c_f32_bf16 v247, v125, v237
  v_dot2c_f32_bf16 v244, v114, v238
  v_dot2c_f32_bf16 v245, v118, v238
  v_dot2c_f32_bf16 v246, v122, v238
  v_dot2c_f32_bf16 v247, v126, v238
  v_dot2c_f32_bf16 v244, v115, v239
  v_dot2c_f32_bf16 v245, v119, v239
  v_dot2c_f32_bf16 v246, v123, v239
  v_dot2c_f32_bf16 v247, v127, v239
  s_lshl_b32 s39, s30, 6
  s_add_u32 s13, s97, 13824
  buffer_load_dwordx4 v[112:115], v9, s[80:83], s13 offen
  s_add_u32 s13, s97, 17280
  buffer_load_dwordx4 v[116:119], v9, s[80:83], s13 offen
  s_add_u32 s13, s97, 20736
  buffer_load_dwordx4 v[120:123], v9, s[80:83], s13 offen
  s_add_u32 s13, s97, 24192
  buffer_load_dwordx4 v[124:127], v9, s[80:83], s13 offen
  v_add_f32_dpp v248, v244, v244 row_ror:8 row_mask:0xf bank_mask:0x3
  v_add_f32_dpp v249, v246, v246 row_ror:8 row_mask:0xf bank_mask:0x3
  s_nop 0
  v_add_f32_dpp v248, v245, v245 row_ror:8 row_mask:0xf bank_mask:0xc
  v_add_f32_dpp v249, v247, v247 row_ror:8 row_mask:0xf bank_mask:0xc
  v_add_u32 v251, s39, v172
  v_add_f32_dpp v250, v248, v248 row_shl:4 row_mask:0xf bank_mask:0x5
  s_nop 1
  v_add_f32_dpp v250, v249, v249 row_shr:4 row_mask:0xf bank_mask:0xa
  s_nop 1
  v_add_f32_dpp v250, v250, v250 quad_perm:[1,0,3,2] row_mask:0xf bank_mask:0xf
  s_nop 1
  v_add_f32_dpp v250, v250, v250 quad_perm:[2,3,0,1] row_mask:0xf bank_mask:0xf
  ds_write_b32 v251, v250
  s_waitcnt vmcnt(44)
  v_dot2_f32_bf16 v244, v128, v236, 0
  v_dot2_f32_bf16 v245, v132, v236, 0
  v_dot2_f32_bf16 v246, v136, v236, 0
  v_dot2_f32_bf16 v247, v140, v236, 0
  v_dot2c_f32_bf16 v244, v129, v237
  v_dot2c_f32_bf16 v245, v133, v237
  v_dot2c_f32_bf16 v246, v137, v237
  v_dot2c_f32_bf16 v247, v141, v237
  v_dot2c_f32_bf16 v244, v130, v238
  v_dot2c_f32_bf16 v245, v134, v238
  v_dot2c_f32_bf16 v246, v138, v238
  v_dot2c_f32_bf16 v247, v142, v238
  v_dot2c_f32_bf16 v244, v131, v239
  v_dot2c_f32_bf16 v245, v135, v239
  v_dot2c_f32_bf16 v246, v139, v239
  v_dot2c_f32_bf16 v247, v143, v239
  s_lshl_b32 s39, s31, 6
  s_add_u32 s13, s97, 27648
  buffer_load_dwordx4 v[128:131], v9, s[80:83], s13 offen
  s_add_u32 s13, s97, 31104
  buffer_load_dwordx4 v[132:135], v9, s[80:83], s13 offen
  s_add_u32 s13, s98, 0
  buffer_load_dwordx4 v[136:139], v12, s[84:87], s13 offen
  s_add_u32 s13, s98, 256
  buffer_load_dwordx4 v[140:143], v12, s[84:87], s13 offen
  v_add_f32_dpp v248, v244, v244 row_ror:8 row_mask:0xf bank_mask:0x3
  v_add_f32_dpp v249, v246, v246 row_ror:8 row_mask:0xf bank_mask:0x3
  s_nop 0
  v_add_f32_dpp v248, v245, v245 row_ror:8 row_mask:0xf bank_mask:0xc
  v_add_f32_dpp v249, v247, v247 row_ror:8 row_mask:0xf bank_mask:0xc
  v_add_u32 v251, s39, v172
  v_add_f32_dpp v250, v248, v248 row_shl:4 row_mask:0xf bank_mask:0x5
  s_nop 1
  v_add_f32_dpp v250, v249, v249 row_shr:4 row_mask:0xf bank_mask:0xa
  s_nop 1
  v_add_f32_dpp v250, v250, v250 quad_perm:[1,0,3,2] row_mask:0xf bank_mask:0xf
  s_nop 1
  v_add_f32_dpp v250, v250, v250 quad_perm:[2,3,0,1] row_mask:0xf bank_mask:0xf
  ds_write_b32 v251, v250
  s_waitcnt vmcnt(32)
  s_add_u32 s10, s22, 110592
  v_add_u32 v13, s10, v2
  ds_read_b128 v[176:179], v13 offset:0
  ds_read_b128 v[180:183], v13 offset:1024
  ds_read_b128 v[184:187], v13 offset:2048
  ds_read_b128 v[188:191], v13 offset:3072
  s_waitcnt lgkmcnt(0)
  v_dot2_f32_bf16 v244, v176, v236, 0
  v_dot2_f32_bf16 v245, v180, v236, 0
  v_dot2_f32_bf16 v246, v184, v236, 0
  v_dot2_f32_bf16 v247, v188, v236, 0
  v_dot2c_f32_bf16 v244, v177, v237
  v_dot2c_f32_bf16 v245, v181, v237
  v_dot2c_f32_bf16 v246, v185, v237
  v_dot2c_f32_bf16 v247, v189, v237
  v_dot2c_f32_bf16 v244, v178, v238
  v_dot2c_f32_bf16 v245, v182, v238
  v_dot2c_f32_bf16 v246, v186, v238
  v_dot2c_f32_bf16 v247, v190, v238
  v_dot2c_f32_bf16 v244, v179, v239
  v_dot2c_f32_bf16 v245, v183, v239
  v_dot2c_f32_bf16 v246, v187, v239
  v_dot2c_f32_bf16 v247, v191, v239
  s_lshr_b32 s39, s22, 6
  s_add_u32 s39, s39, 3584
  v_add_f32_dpp v248, v244, v244 row_ror:8 row_mask:0xf bank_mask:0x3
  v_add_f32_dpp v249, v246, v246 row_ror:8 row_mask:0xf bank_mask:0x3
  s_nop 0
  v_add_f32_dpp v248, v245, v245 row_ror:8 row_mask:0xf bank_mask:0xc
  v_add_f32_dpp v249, v247, v247 row_ror:8 row_mask:0xf bank_mask:0xc
  v_add_u32 v251, s39, v172
  v_add_f32_dpp v250, v248, v248 row_shl:4 row_mask:0xf bank_mask:0x5
  s_nop 1
  v_add_f32_dpp v250, v249, v249 row_shr:4 row_mask:0xf bank_mask:0xa
  s_nop 1
  v_add_f32_dpp v250, v250, v250 quad_perm:[1,0,3,2] row_mask:0xf bank_mask:0xf
  s_nop 1
  v_add_f32_dpp v250, v250, v250 quad_perm:[2,3,0,1] row_mask:0xf bank_mask:0xf
  ds_write_b32 v251, v250
  s_add_u32 s10, s22, 81920
  v_add_u32 v13, s10, v2
  ds_read_b128 v[176:179], v13 offset:0
  ds_read_b128 v[180:183], v13 offset:1024
  ds_read_b128 v[184:187], v13 offset:2048
  ds_read_b128 v[188:191], v13 offset:3072
  s_waitcnt lgkmcnt(0)
  v_dot2_f32_bf16 v244, v176, v236, 0
  v_dot2_f32_bf16 v245, v180, v236, 0
  v_dot2_f32_bf16 v246, v184, v236, 0
  v_dot2_f32_bf16 v247, v188, v236, 0
  v_dot2c_f32_bf16 v244, v177, v237
  v_dot2c_f32_bf16 v245, v181, v237
  v_dot2c_f32_bf16 v246, v185, v237
  v_dot2c_f32_bf16 v247, v189, v237
  v_dot2c_f32_bf16 v244, v178, v238
  v_dot2c_f32_bf16 v245, v182, v238
  v_dot2c_f32_bf16 v246, v186, v238
  v_dot2c_f32_bf16 v247, v190, v238
  v_dot2c_f32_bf16 v244, v179, v239
  v_dot2c_f32_bf16 v245, v183, v239
  v_dot2c_f32_bf16 v246, v187, v239
  v_dot2c_f32_bf16 v247, v191, v239
  s_lshr_b32 s39, s22, 6
  s_add_u32 s39, s39, 4032
  v_add_f32_dpp v248, v244, v244 row_ror:8 row_mask:0xf bank_mask:0x3
  v_add_f32_dpp v249, v246, v246 row_ror:8 row_mask:0xf bank_mask:0x3
  s_nop 0
  v_add_f32_dpp v248, v245, v245 row_ror:8 row_mask:0xf bank_mask:0xc
  v_add_f32_dpp v249, v247, v247 row_ror:8 row_mask:0xf bank_mask:0xc
  v_add_u32 v251, s39, v172
  v_add_f32_dpp v250, v248, v248 row_shl:4 row_mask:0xf bank_mask:0x5
  s_nop 1
  v_add_f32_dpp v250, v249, v249 row_shr:4 row_mask:0xf bank_mask:0xa
  s_nop 1
  v_add_f32_dpp v250, v250, v250 quad_perm:[1,0,3,2] row_mask:0xf bank_mask:0xf
  s_nop 1
  v_add_f32_dpp v250, v250, v250 quad_perm:[2,3,0,1] row_mask:0xf bank_mask:0xf
  ds_write_b32 v251, v250
  s_add_u32 s10, s22, 53248
  v_add_u32 v13, s10, v2
  ds_read_b128 v[176:179], v13 offset:0
  ds_read_b128 v[180:183], v13 offset:1024
  ds_read_b128 v[184:187], v13 offset:2048
  ds_read_b128 v[188:191], v13 offset:3072
  s_waitcnt lgkmcnt(0)
  v_dot2_f32_bf16 v244, v176, v236, 0
  v_dot2_f32_bf16 v245, v180, v236, 0
  v_dot2_f32_bf16 v246, v184, v236, 0
  v_dot2_f32_bf16 v247, v188, v236, 0
  v_dot2c_f32_bf16 v244, v177, v237
  v_dot2c_f32_bf16 v245, v181, v237
  v_dot2c_f32_bf16 v246, v185, v237
  v_dot2c_f32_bf16 v247, v189, v237
  v_dot2c_f32_bf16 v244, v178, v238
  v_dot2c_f32_bf16 v245, v182, v238
  v_dot2c_f32_bf16 v246, v186, v238
  v_dot2c_f32_bf16 v247, v190, v238
  v_dot2c_f32_bf16 v244, v179, v239
  v_dot2c_f32_bf16 v245, v183, v239
  v_dot2c_f32_bf16 v246, v187, v239
  v_dot2c_f32_bf16 v247, v191, v239
  s_lshr_b32 s39, s22, 6
  s_add_u32 s39, s39, 4480
  v_add_f32_dpp v248, v244, v244 row_ror:8 row_mask:0xf bank_mask:0x3
  v_add_f32_dpp v249, v246, v246 row_ror:8 row_mask:0xf bank_mask:0x3
  s_nop 0
  v_add_f32_dpp v248, v245, v245 row_ror:8 row_mask:0xf bank_mask:0xc
  v_add_f32_dpp v249, v247, v247 row_ror:8 row_mask:0xf bank_mask:0xc
  v_add_u32 v251, s39, v172
  v_add_f32_dpp v250, v248, v248 row_shl:4 row_mask:0xf bank_mask:0x5
  s_nop 1
  v_add_f32_dpp v250, v249, v249 row_shr:4 row_mask:0xf bank_mask:0xa
  s_nop 1
  v_add_f32_dpp v250, v250, v250 quad_perm:[1,0,3,2] row_mask:0xf bank_mask:0xf
  s_nop 1
  v_add_f32_dpp v250, v250, v250 quad_perm:[2,3,0,1] row_mask:0xf bank_mask:0xf
  ds_write_b32 v251, v250
  s_add_u32 s10, s22, 24576
  v_add_u32 v13, s10, v2
  ds_read_b128 v[176:179], v13 offset:0
  ds_read_b128 v[180:183], v13 offset:1024
  ds_read_b128 v[184:187], v13 offset:2048
  ds_read_b128 v[188:191], v13 offset:3072
  s_waitcnt lgkmcnt(0)
  v_dot2_f32_bf16 v244, v176, v236, 0
  v_dot2_f32_bf16 v245, v180, v236, 0
  v_dot2_f32_bf16 v246, v184, v236, 0
  v_dot2_f32_bf16 v247, v188, v236, 0
  v_dot2c_f32_bf16 v244, v177, v237
  v_dot2c_f32_bf16 v245, v181, v237
  v_dot2c_f32_bf16 v246, v185, v237
  v_dot2c_f32_bf16 v247, v189, v237
  v_dot2c_f32_bf16 v244, v178, v238
  v_dot2c_f32_bf16 v245, v182, v238
  v_dot2c_f32_bf16 v246, v186, v238
  v_dot2c_f32_bf16 v247, v190, v238
  v_dot2c_f32_bf16 v244, v179, v239
  v_dot2c_f32_bf16 v245, v183, v239
  v_dot2c_f32_bf16 v246, v187, v239
  v_dot2c_f32_bf16 v247, v191, v239
  s_lshr_b32 s39, s22, 6
  s_add_u32 s39, s39, 4928
  v_add_f32_dpp v248, v244, v244 row_ror:8 row_mask:0xf bank_mask:0x3
  v_add_f32_dpp v249, v246, v246 row_ror:8 row_mask:0xf bank_mask:0x3
  s_nop 0
  v_add_f32_dpp v248, v245, v245 row_ror:8 row_mask:0xf bank_mask:0xc
  v_add_f32_dpp v249, v247, v247 row_ror:8 row_mask:0xf bank_mask:0xc
  v_add_u32 v251, s39, v172
  v_add_f32_dpp v250, v248, v248 row_shl:4 row_mask:0xf bank_mask:0x5
  s_nop 1
  v_add_f32_dpp v250, v249, v249 row_shr:4 row_mask:0xf bank_mask:0xa
  s_nop 1
  v_add_f32_dpp v250, v250, v250 quad_perm:[1,0,3,2] row_mask:0xf bank_mask:0xf
  s_nop 1
  v_add_f32_dpp v250, v250, v250 quad_perm:[2,3,0,1] row_mask:0xf bank_mask:0xf
  ds_write_b32 v251, v250
  s_mov_b32 s24, 0x200
  s_mov_b32 s25, 0x200
  s_mov_b32 s26, 0x200
  s_mov_b32 s27, 0x200
  s_mov_b32 s28, 0x200
  s_mov_b32 s29, 0x200
  s_mov_b32 s30, 0x200
  s_mov_b32 s31, 0x200
  s_branch L_kexit2
L_w0pro:
  s_nop 7
  s_add_u32 s13, s96, 0
  buffer_load_dwordx4 v[16:19], v8, s[76:79], s13 offen
  s_add_u32 s13, s96, 256
  buffer_load_dwordx4 v[20:23], v8, s[76:79], s13 offen
  s_add_u32 s13, s96, 512
  buffer_load_dwordx4 v[24:27], v8, s[76:79], s13 offen
  s_add_u32 s13, s96, 768
  buffer_load_dwordx4 v[28:31], v8, s[76:79], s13 offen
  s_add_u32 s13, s96, 1024
  buffer_load_dwordx4 v[32:35], v8, s[76:79], s13 offen
  s_add_u32 s13, s96, 1280
  buffer_load_dwordx4 v[36:39], v8, s[76:79], s13 offen
  s_add_u32 s13, s96, 1536
  buffer_load_dwordx4 v[40:43], v8, s[76:79], s13 offen
  s_add_u32 s13, s96, 1792
  buffer_load_dwordx4 v[44:47], v8, s[76:79], s13 offen
  s_add_u32 s13, s96, 2048
  buffer_load_dwordx4 v[48:51], v8, s[76:79], s13 offen
  s_add_u32 s13, s96, 2304
  buffer_load_dwordx4 v[52:55], v8, s[76:79], s13 offen
  s_add_u32 s13, s96, 2560
  buffer_load_dwordx4 v[56:59], v8, s[76:79], s13 offen
  s_add_u32 s13, s96, 2816
  buffer_load_dwordx4 v[60:63], v8, s[76:79], s13 offen
  s_add_u32 s13, s96, 3072
  buffer_load_dwordx4 v[64:67], v8, s[76:79], s13 offen
  s_add_u32 s13, s96, 3328
  buffer_load_dwordx4 v[68:71], v8, s[76:79], s13 offen
  s_add_u32 s13, s96, 3584
  buffer_load_dwordx4 v[72:75], v8, s[76:79], s13 offen
  s_add_u32 s13, s96, 3840
  buffer_load_dwordx4 v[76:79], v8, s[76:79], s13 offen
  s_mov_b32 exec_lo, 1
  s_mov_b32 exec_hi, 0
  ds_add_rtn_u32 v252, v174, v175 offset:8776
  s_mov_b32 exec_lo, -1
  s_mov_b32 exec_hi, -1
  s_waitcnt lgkmcnt(0)
  v_readfirstlane_b32 s36, v252
  s_nop 3
  s_cmp_lt_u32 s36, 0x100
  s_cselect_b64 s[32:33], s[44:45], s[48:49]
  s_and_b32 s37, s36, 0xff
  s_lshl_b32 s37, s37, 12
  buffer_load_dwordx4 v[112:115], v2, s[32:35], s37 offen offset:0 nt
  buffer_load_dwordx4 v[116:119], v2, s[32:35], s37 offen offset:1024 nt
  buffer_load_dwordx4 v[120:123], v2, s[32:35], s37 offen offset:2048 nt
  buffer_load_dwordx4 v[124:127], v2, s[32:35], s37 offen offset:3072 nt
  s_mov_b32 s30, s36
  s_mov_b32 exec_lo, 1
  s_mov_b32 exec_hi, 0
  ds_add_rtn_u32 v252, v174, v175 offset:8776
  s_mov_b32 exec_lo, -1
  s_mov_b32 exec_hi, -1
  s_waitcnt lgkmcnt(0)
  v_readfirstlane_b32 s36, v252
  s_nop 3
  s_cmp_lt_u32 s36, 0x100
  s_cselect_b64 s[32:33], s[44:45], s[48:49]
  s_and_b32 s37, s36, 0xff
  s_lshl_b32 s37, s37, 12
  buffer_load_dwordx4 v[128:131], v2, s[32:35], s37 offen offset:0 nt
  buffer_load_dwordx4 v[132:135], v2, s[32:35], s37 offen offset:1024 nt
  buffer_load_dwordx4 v[136:139], v2, s[32:35], s37 offen offset:2048 nt
  buffer_load_dwordx4 v[140:143], v2, s[32:35], s37 offen offset:3072 nt
  s_mov_b32 s31, s36
  v_mov_b32 v232, 0
  s_mov_b32 s23, 0
L_kloop:
  s_nop 7
  s_cmp_ge_u32 s30, 0x100
  s_cbranch_scc1 L_kexit
  s_mov_b32 exec_lo, 1
  s_mov_b32 exec_hi, 0
  ds_add_rtn_u32 v252, v174, v175 offset:8776
  s_mov_b32 exec_lo, -1
  s_mov_b32 exec_hi, -1
  s_waitcnt vmcnt(4)
  v_dot2_f32_bf16 v244, v112, v236, 0
  v_dot2_f32_bf16 v245, v116, v236, 0
  v_dot2_f32_bf16 v246, v120, v236, 0
  v_dot2_f32_bf16 v247, v124, v236, 0
  v_dot2c_f32_bf16 v244, v113, v237
  v_dot2c_f32_bf16 v245, v117, v237
  v_dot2c_f32_bf16 v246, v121, v237
  v_dot2c_f32_bf16 v247, v125, v237
  v_dot2c_f32_bf16 v244, v114, v238
  v_dot2c_f32_bf16 v245, v118, v238
  v_dot2c_f32_bf16 v246, v122, v238
  v_dot2c_f32_bf16 v247, v126, v238
  v_dot2c_f32_bf16 v244, v115, v239
  v_dot2c_f32_bf16 v245, v119, v239
  v_dot2c_f32_bf16 v246, v123, v239
  v_dot2c_f32_bf16 v247, v127, v239
  s_waitcnt lgkmcnt(0)
  v_readfirstlane_b32 s36, v252
  s_nop 3
  s_cmp_lt_u32 s36, 0x100
  s_cselect_b64 s[32:33], s[44:45], s[48:49]
  s_and_b32 s37, s36, 0xff
  s_lshl_b32 s37, s37, 12
  s_lshl_b32 s39, s30, 6
  buffer_load_dwordx4 v[112:115], v2, s[32:35], s37 offen offset:0 nt
  buffer_load_dwordx4 v[116:119], v2, s[32:35], s37 offen offset:1024 nt
  buffer_load_dwordx4 v[120:123], v2, s[32:35], s37 offen offset:2048 nt
  buffer_load_dwordx4 v[124:127], v2, s[32:35], s37 offen offset:3072 nt
  v_add_f32_dpp v248, v244, v244 row_ror:8 row_mask:0xf bank_mask:0x3
  v_add_f32_dpp v249, v246, v246 row_ror:8 row_mask:0xf bank_mask:0x3
  s_nop 0
  v_add_f32_dpp v248, v245, v245 row_ror:8 row_mask:0xf bank_mask:0xc
  v_add_f32_dpp v249, v247, v247 row_ror:8 row_mask:0xf bank_mask:0xc
  v_add_u32 v251, s39, v172
  v_add_f32_dpp v250, v248, v248 row_shl:4 row_mask:0xf bank_mask:0x5
  s_nop 1
  v_add_f32_dpp v250, v249, v249 row_shr:4 row_mask:0xf bank_mask:0xa
  s_nop 1
  v_add_f32_dpp v250, v250, v250 quad_perm:[1,0,3,2] row_mask:0xf bank_mask:0xf
  s_nop 1
  v_add_f32_dpp v250, v250, v250 quad_perm:[2,3,0,1] row_mask:0xf bank_mask:0xf
  ds_write_b32 v251, v250
  s_mov_b32 s30, s36
  s_cmp_lg_u32 s23, 0
  s_cbranch_scc1 L_noall
  s_cmp_lt_u32 s36, 0x80
  s_cbranch_scc1 L_noall
  s_mov_b32 s23, 1
  v_mov_b32 v13, 252
  buffer_load_dword v232, v13, s[64:67], 0 offen sc1
L_noall:
  s_nop 7
  s_cmp_ge_u32 s31, 0x100
  s_cbranch_scc1 L_kexit
  s_mov_b32 exec_lo, 1
  s_mov_b32 exec_hi, 0
  ds_add_rtn_u32 v252, v174, v175 offset:8776
  s_mov_b32 exec_lo, -1
  s_mov_b32 exec_hi, -1
  s_waitcnt vmcnt(4)
  v_dot2_f32_bf16 v244, v128, v236, 0
  v_dot2_f32_bf16 v245, v132, v236, 0
  v_dot2_f32_bf16 v246, v136, v236, 0
  v_dot2_f32_bf16 v247, v140, v236, 0
  v_dot2c_f32_bf16 v244, v129, v237
  v_dot2c_f32_bf16 v245, v133, v237
  v_dot2c_f32_bf16 v246, v137, v237
  v_dot2c_f32_bf16 v247, v141, v237
  v_dot2c_f32_bf16 v244, v130, v238
  v_dot2c_f32_bf16 v245, v134, v238
  v_dot2c_f32_bf16 v246, v138, v238
  v_dot2c_f32_bf16 v247, v142, v238
  v_dot2c_f32_bf16 v244, v131, v239
  v_dot2c_f32_bf16 v245, v135, v239
  v_dot2c_f32_bf16 v246, v139, v239
  v_dot2c_f32_bf16 v247, v143, v239
  s_waitcnt lgkmcnt(0)
  v_readfirstlane_b32 s36, v252
  s_nop 3
  s_cmp_lt_u32 s36, 0x100
  s_cselect_b64 s[32:33], s[44:45], s[48:49]
  s_and_b32 s37, s36, 0xff
  s_lshl_b32 s37, s37, 12
  s_lshl_b32 s39, s31, 6
  buffer_load_dwordx4 v[128:131], v2, s[32:35], s37 offen offset:0 nt
  buffer_load_dwordx4 v[132:135], v2, s[32:35], s37 offen offset:1024 nt
  buffer_load_dwordx4 v[136:139], v2, s[32:35], s37 offen offset:2048 nt
  buffer_load_dwordx4 v[140:143], v2, s[32:35], s37 offen offset:3072 nt
  v_add_f32_dpp v248, v244, v244 row_ror:8 row_mask:0xf bank_mask:0x3
  v_add_f32_dpp v249, v246, v246 row_ror:8 row_mask:0xf bank_mask:0x3
  s_nop 0
  v_add_f32_dpp v248, v245, v245 row_ror:8 row_mask:0xf bank_mask:0xc
  v_add_f32_dpp v249, v247, v247 row_ror:8 row_mask:0xf bank_mask:0xc
  v_add_u32 v251, s39, v172
  v_add_f32_dpp v250, v248, v248 row_shl:4 row_mask:0xf bank_mask:0x5
  s_nop 1
  v_add_f32_dpp v250, v249, v249 row_shr:4 row_mask:0xf bank_mask:0xa
  s_nop 1
  v_add_f32_dpp v250, v250, v250 quad_perm:[1,0,3,2] row_mask:0xf bank_mask:0xf
  s_nop 1
  v_add_f32_dpp v250, v250, v250 quad_perm:[2,3,0,1] row_mask:0xf bank_mask:0xf
  ds_write_b32 v251, v250
  s_mov_b32 s31, s36
  s_branch L_kloop
L_kexit:
  s_nop 7
  s_mov_b32 exec_lo, 1
  s_mov_b32 exec_hi, 0
  ds_add_rtn_u32 v252, v174, v175 offset:8776
  s_mov_b32 exec_lo, -1
  s_mov_b32 exec_hi, -1
  s_waitcnt lgkmcnt(0)
  v_readfirstlane_b32 s36, v252
  s_nop 3
  s_cmp_lt_u32 s36, 0x100
  s_cselect_b64 s[32:33], s[44:45], s[48:49]
  s_and_b32 s37, s36, 0xff
  s_lshl_b32 s37, s37, 12
  buffer_load_dwordx4 v[96:99], v2, s[32:35], s37 offen offset:0 nt
  buffer_load_dwordx4 v[100:103], v2, s[32:35], s37 offen offset:1024 nt
  buffer_load_dwordx4 v[104:107], v2, s[32:35], s37 offen offset:2048 nt
  buffer_load_dwordx4 v[108:111], v2, s[32:35], s37 offen offset:3072 nt
  s_mov_b32 s29, s36
  s_mov_b32 exec_lo, 1
  s_mov_b32 exec_hi, 0
  ds_add_rtn_u32 v252, v174, v175 offset:8776
  s_mov_b32 exec_lo, -1
  s_mov_b32 exec_hi, -1
  s_waitcnt lgkmcnt(0)
  v_readfirstlane_b32 s36, v252
  s_nop 3
  s_cmp_lt_u32 s36, 0x100
  s_cselect_b64 s[32:33], s[44:45], s[48:49]
  s_and_b32 s37, s36, 0xff
  s_lshl_b32 s37, s37, 12
  buffer_load_dwordx4 v[80:83], v2, s[32:35], s37 offen offset:0 nt
  buffer_load_dwordx4 v[84:87], v2, s[32:35], s37 offen offset:1024 nt
  buffer_load_dwordx4 v[88:91], v2, s[32:35], s37 offen offset:2048 nt
  buffer_load_dwordx4 v[92:95], v2, s[32:35], s37 offen offset:3072 nt
  s_mov_b32 s28, s36
L_kexit2:
  s_nop 7
  s_cmp_lg_u32 s3, 0
  s_cbranch_scc1 L_all_ok
  s_waitcnt vmcnt(8)
  s_mov_b32 s95, 0
  v_mov_b32 v13, 252
L_all_loop:
  s_nop 7
  v_cmp_gt_u32 vcc, 0x100, v232
  s_cbranch_vccz L_all_ok
  s_sleep 8
  buffer_load_dword v232, v13, s[64:67], 0 offen sc1
  s_waitcnt vmcnt(0)
  s_add_u32 s95, s95, 1
  s_cmp_lt_u32 s95, 200000
  s_cbranch_scc1 L_all_loop
L_all_ok:
  s_nop 7
  s_waitcnt lgkmcnt(0)
  s_barrier
  s_lshl_b32 s12, s3, 11
  s_add_u32 s12, s12, 139264
  v_lshlrev_b32 v171, 5, v1
  v_add_u32 v171, s12, v171
  ds_read_b128 v[144:147], v171
  ds_read_b128 v[148:151], v171 offset:16
  v_lshlrev_b32 v13, 4, v1
  v_cmp_gt_u32 vcc, 40, v1
  v_mov_b32 v15, 0x7fffffff
  s_nop 0
  v_cndmask_b32 v13, v15, v13, vcc
  s_mul_i32 s10, s4, 15360
  s_mul_i32 s11, s3, 640
  s_add_u32 s10, s10, s11
  s_add_u32 s11, s10, 7680
  buffer_load_dwordx4 v[208:211], v13, s[60:63], s11 offen sc1
  s_add_u32 s11, s10, 130560
  buffer_load_dwordx4 v[212:215], v13, s[60:63], s11 offen sc1
  s_add_u32 s11, s10, 253440
  buffer_load_dwordx4 v[216:219], v13, s[60:63], s11 offen sc1
  s_add_u32 s11, s10, 376320
  buffer_load_dwordx4 v[220:223], v13, s[60:63], s11 offen sc1
  v_lshrrev_b32 v13, 5, v1
  v_mul_u32_u24 v13, 7680, v13
  v_bfe_u32 v15, v1, 3, 2
  v_mul_u32_u24 v15, 122880, v15
  v_add_u32 v13, v13, v15
  v_and_b32 v15, 7, v1
  v_lshl_add_u32 v13, v15, 4, v13
  s_mul_i32 s10, s4, 15360
  s_lshl_b32 s11, s5, 7
  s_add_u32 s10, s10, s11
  s_add_u32 s10, s10, 5120
  buffer_load_dwordx4 v[224:227], v13, s[60:63], s10 offen sc1
  v_lshlrev_b32 v13, 3, v1
  s_mul_i32 s10, s4, 1280
  s_lshl_b32 s11, s5, 6
  s_add_u32 s10, s10, s11
  buffer_load_dwordx2 v[228:229], v13, s[72:75], s10 offen
  s_add_u32 s13, s98, 512
  buffer_load_dwordx4 v[176:179], v12, s[84:87], s13 offen
  s_add_u32 s13, s98, 768
  buffer_load_dwordx4 v[180:183], v12, s[84:87], s13 offen
  s_add_u32 s13, s98, 1024
  buffer_load_dwordx4 v[184:187], v12, s[84:87], s13 offen
  s_add_u32 s13, s98, 1280
  buffer_load_dwordx4 v[188:191], v12, s[84:87], s13 offen
  s_add_u32 s13, s98, 1536
  buffer_load_dwordx4 v[192:195], v12, s[84:87], s13 offen
  s_add_u32 s13, s98, 1792
  buffer_load_dwordx4 v[196:199], v12, s[84:87], s13 offen
  s_add_u32 s13, s98, 2048
  buffer_load_dwordx4 v[200:203], v12, s[84:87], s13 offen
  s_add_u32 s13, s98, 2304
  buffer_load_dwordx4 v[204:207], v12, s[84:87], s13 offen
  s_mov_b32 s10, 0x3db504f3
  s_mov_b32 s11, 0x3fb8aa3b
  s_waitcnt lgkmcnt(0)
  v_cvt_pk_bf16_f32 v252, v144, v145
  v_lshlrev_b32 v144, 16, v252
  v_and_b32 v145, 0xffff0000, v252
  v_mul_f32 v144, s10, v144
  v_mul_f32 v145, s10, v145
  v_cvt_pk_bf16_f32 v253, v144, v145
  v_lshlrev_b32 v144, 16, v253
  v_and_b32 v145, 0xffff0000, v253
  v_cvt_pk_bf16_f32 v252, v146, v147
  v_lshlrev_b32 v146, 16, v252
  v_and_b32 v147, 0xffff0000, v252
  v_mul_f32 v146, s10, v146
  v_mul_f32 v147, s10, v147
  v_cvt_pk_bf16_f32 v253, v146, v147
  v_lshlrev_b32 v146, 16, v253
  v_and_b32 v147, 0xffff0000, v253
  v_cvt_pk_bf16_f32 v252, v148, v149
  v_lshlrev_b32 v148, 16, v252
  v_and_b32 v149, 0xffff0000, v252
  v_mul_f32 v148, s10, v148
  v_mul_f32 v149, s10, v149
  v_cvt_pk_bf16_f32 v253, v148, v149
  v_lshlrev_b32 v148, 16, v253
  v_and_b32 v149, 0xffff0000, v253
  v_cvt_pk_bf16_f32 v252, v150, v151
  v_lshlrev_b32 v150, 16, v252
  v_and_b32 v151, 0xffff0000, v252
  v_mul_f32 v150, s10, v150
  v_mul_f32 v151, s10, v151
  v_cvt_pk_bf16_f32 v253, v150, v151
  v_lshlrev_b32 v150, 16, v253
  v_and_b32 v151, 0xffff0000, v253
  v_max3_f32 v252, v144, v145, v146
  v_max3_f32 v252, v252, v147, v148
  v_max3_f32 v252, v252, v149, v150
  v_max_f32 v252, v252, v151
  s_nop 1
  v_max_f32_dpp v252, v252, v252 quad_perm:[1,0,3,2] row_mask:0xf bank_mask:0xf
  s_nop 1
  v_max_f32_dpp v252, v252, v252 quad_perm:[2,3,0,1] row_mask:0xf bank_mask:0xf
  s_nop 1
  v_max_f32_dpp v252, v252, v252 row_ror:4 row_mask:0xf bank_mask:0xf
  s_nop 1
  v_max_f32_dpp v252, v252, v252 row_ror:8 row_mask:0xf bank_mask:0xf
  v_mov_b32 v253, v252
  s_nop 1
  v_permlane16_swap_b32 v252, v253
  v_max_f32 v252, v252, v253
  v_mov_b32 v253, v252
  s_nop 1
  v_permlane32_swap_b32 v252, v253
  v_max_f32 v252, v252, v253
  v_mov_b32 v254, 0
  v_sub_f32 v244, v144, v252
  v_mul_f32 v244, s11, v244
  v_exp_f32 v244, v244
  s_nop 0
  v_add_f32 v254, v254, v244
  v_sub_f32 v245, v145, v252
  v_mul_f32 v245, s11, v245
  v_exp_f32 v245, v245
  s_nop 0
  v_add_f32 v254, v254, v245
  v_sub_f32 v246, v146, v252
  v_mul_f32 v246, s11, v246
  v_exp_f32 v246, v246
  s_nop 0
  v_add_f32 v254, v254, v246
  v_sub_f32 v247, v147, v252
  v_mul_f32 v247, s11, v247
  v_exp_f32 v247, v247
  s_nop 0
  v_add_f32 v254, v254, v247
  v_sub_f32 v244, v148, v252
  v_mul_f32 v244, s11, v244
  v_exp_f32 v244, v244
  s_nop 0
  v_add_f32 v254, v254, v244
  v_sub_f32 v245, v149, v252
  v_mul_f32 v245, s11, v245
  v_exp_f32 v245, v245
  s_nop 0
  v_add_f32 v254, v254, v245
  v_sub_f32 v246, v150, v252
  v_mul_f32 v246, s11, v246
  v_exp_f32 v246, v246
  s_nop 0
  v_add_f32 v254, v254, v246
  v_sub_f32 v247, v151, v252
  v_mul_f32 v247, s11, v247
  v_exp_f32 v247, v247
  s_nop 0
  v_add_f32 v254, v254, v247
  s_nop 1
  v_add_f32_dpp v254, v254, v254 quad_perm:[1,0,3,2] row_mask:0xf bank_mask:0xf
  s_nop 1
  v_add_f32_dpp v254, v254, v254 quad_perm:[2,3,0,1] row_mask:0xf bank_mask:0xf
  s_nop 1
  v_add_f32_dpp v254, v254, v254 row_ror:4 row_mask:0xf bank_mask:0xf
  s_nop 1
  v_add_f32_dpp v254, v254, v254 row_ror:8 row_mask:0xf bank_mask:0xf
  v_mov_b32 v253, v254
  s_nop 1
  v_permlane16_swap_b32 v254, v253
  v_add_f32 v254, v254, v253
  v_mov_b32 v253, v254
  s_nop 1
  v_permlane32_swap_b32 v254, v253
  v_add_f32 v254, v254, v253
  v_mov_b32 v253, v254
  s_lshl_b32 s12, s3, 3
  v_mov_b32 v15, s12
  s_mov_b32 exec_lo, 1
  s_mov_b32 exec_hi, 0
  ds_write_b64 v15, v[252:253] offset:8448
  s_mov_b32 exec_lo, -1
  s_mov_b32 exec_hi, -1
  s_waitcnt lgkmcnt(0)
  s_barrier
  ds_read_b128 v[152:155], v174 offset:8448
  ds_read_b128 v[156:159], v174 offset:8464
  ds_read_b128 v[160:163], v174 offset:8480
  ds_read_b128 v[164:167], v174 offset:8496
  s_waitcnt lgkmcnt(0)
  v_max3_f32 v252, v152, v154, v156
  v_max3_f32 v252, v252, v158, v160
  v_max3_f32 v252, v252, v162, v164
  v_max_f32 v252, v252, v166
  v_mov_b32 v254, 0
  v_sub_f32 v244, v152, v252
  v_mul_f32 v244, s11, v244
  v_exp_f32 v244, v244
  s_nop 0
  v_fmac_f32 v254, v244, v153
  v_sub_f32 v245, v154, v252
  v_mul_f32 v245, s11, v245
  v_exp_f32 v245, v245
  s_nop 0
  v_fmac_f32 v254, v245, v155
  v_sub_f32 v246, v156, v252
  v_mul_f32 v246, s11, v246
  v_exp_f32 v246, v246
  s_nop 0
  v_fmac_f32 v254, v246, v157
  v_sub_f32 v247, v158, v252
  v_mul_f32 v247, s11, v247
  v_exp_f32 v247, v247
  s_nop 0
  v_fmac_f32 v254, v247, v159
  v_sub_f32 v244, v160, v252
  v_mul_f32 v244, s11, v244
  v_exp_f32 v244, v244
  s_nop 0
  v_fmac_f32 v254, v244, v161
  v_sub_f32 v245, v162, v252
  v_mul_f32 v245, s11, v245
  v_exp_f32 v245, v245
  s_nop 0
  v_fmac_f32 v254, v245, v163
  v_sub_f32 v246, v164, v252
  v_mul_f32 v246, s11, v246
  v_exp_f32 v246, v246
  s_nop 0
  v_fmac_f32 v254, v246, v165
  v_sub_f32 v247, v166, v252
  v_mul_f32 v247, s11, v247
  v_exp_f32 v247, v247
  s_nop 0
  v_fmac_f32 v254, v247, v167
  v_rcp_f32 v254, v254
  v_sub_f32 v144, v144, v252
  v_sub_f32 v145, v145, v252
  v_sub_f32 v146, v146, v252
  v_sub_f32 v147, v147, v252
  v_sub_f32 v148, v148, v252
  v_sub_f32 v149, v149, v252
  v_sub_f32 v150, v150, v252
  v_sub_f32 v151, v151, v252
  v_mul_f32 v144, s11, v144
  v_mul_f32 v145, s11, v145
  v_mul_f32 v146, s11, v146
  v_mul_f32 v147, s11, v147
  v_mul_f32 v148, s11, v148
  v_mul_f32 v149, s11, v149
  v_mul_f32 v150, s11, v150
  v_mul_f32 v151, s11, v151
  v_exp_f32 v144, v144
  v_exp_f32 v145, v145
  v_exp_f32 v146, v146
  v_exp_f32 v147, v147
  v_exp_f32 v148, v148
  v_exp_f32 v149, v149
  v_exp_f32 v150, v150
  v_exp_f32 v151, v151
  v_mul_f32 v144, v144, v254
  v_mul_f32 v145, v145, v254
  v_mul_f32 v146, v146, v254
  v_mul_f32 v147, v147, v254
  v_mul_f32 v148, v148, v254
  v_mul_f32 v149, v149, v254
  v_mul_f32 v150, v150, v254
  v_mul_f32 v151, v151, v254
  v_cvt_pk_bf16_f32 v144, v144, v144
  v_cvt_pk_bf16_f32 v145, v145, v145
  v_cvt_pk_bf16_f32 v146, v146, v146
  v_cvt_pk_bf16_f32 v147, v147, v147
  v_cvt_pk_bf16_f32 v148, v148, v148
  v_cvt_pk_bf16_f32 v149, v149, v149
  v_cvt_pk_bf16_f32 v150, v150, v150
  v_cvt_pk_bf16_f32 v151, v151, v151
  ds_write_b128 v171, v[144:147]
  ds_write_b128 v171, v[148:151] offset:16
  v_mov_b32 v240, 0
  v_mov_b32 v241, 0
  v_mov_b32 v242, 0
  v_mov_b32 v243, 0
  s_waitcnt lgkmcnt(0)
  s_barrier
  s_waitcnt vmcnt(8)
  v_add_f32 v208, v208, v212
  v_add_f32 v216, v216, v220
  v_add_f32 v208, v208, v216
  v_add_f32 v209, v209, v213
  v_add_f32 v217, v217, v221
  v_add_f32 v209, v209, v217
  v_add_f32 v210, v210, v214
  v_add_f32 v218, v218, v222
  v_add_f32 v210, v210, v218
  v_add_f32 v211, v211, v215
  v_add_f32 v219, v219, v223
  v_add_f32 v211, v211, v219
  v_cvt_pk_bf16_f32 v252, v208, v209
  v_lshlrev_b32 v208, 16, v252
  v_and_b32 v209, 0xffff0000, v252
  v_cvt_pk_bf16_f32 v252, v210, v211
  v_lshlrev_b32 v210, 16, v252
  v_and_b32 v211, 0xffff0000, v252
  s_cmp_lt_u32 s3, 4
  s_cbranch_scc1 L_aux1
  v_add_f32 v208, 1.0, v208
  v_add_f32 v209, 1.0, v209
  v_add_f32 v210, 1.0, v210
  v_add_f32 v211, 1.0, v211
  v_cvt_pk_bf16_f32 v252, v208, v209
  v_lshlrev_b32 v208, 16, v252
  v_and_b32 v209, 0xffff0000, v252
  v_cvt_pk_bf16_f32 v252, v210, v211
  v_lshlrev_b32 v210, 16, v252
  v_and_b32 v211, 0xffff0000, v252
L_aux1:
  s_nop 7
  s_mul_i32 s10, s3, 640
  v_lshlrev_b32 v13, 4, v1
  v_add_u32 v13, s10, v13
  s_mov_b32 exec_lo, -1
  s_mov_b32 exec_hi, 0xff
  ds_write_b128 v13, v[208:211] offset:13312
  s_mov_b32 exec_lo, -1
  s_mov_b32 exec_hi, -1
  v_add_f32_dpp v224, v224, v224 row_ror:8 row_mask:0xf bank_mask:0xf
  v_add_f32_dpp v225, v225, v225 row_ror:8 row_mask:0xf bank_mask:0xf
  v_add_f32_dpp v226, v226, v226 row_ror:8 row_mask:0xf bank_mask:0xf
  v_add_f32_dpp v227, v227, v227 row_ror:8 row_mask:0xf bank_mask:0xf
  v_mov_b32 v252, v224
  v_mov_b32 v253, v225
  v_mov_b32 v254, v226
  v_mov_b32 v255, v227
  v_permlane16_swap_b32 v224, v252
  v_permlane16_swap_b32 v225, v253
  v_permlane16_swap_b32 v226, v254
  v_permlane16_swap_b32 v227, v255
  v_add_f32 v224, v224, v252
  v_add_f32 v225, v225, v253
  v_add_f32 v226, v226, v254
  v_add_f32 v227, v227, v255
  v_cvt_pk_bf16_f32 v252, v224, v225
  v_lshlrev_b32 v224, 16, v252
  v_and_b32 v225, 0xffff0000, v252
  v_cvt_pk_bf16_f32 v252, v226, v227
  v_lshlrev_b32 v226, 16, v252
  v_and_b32 v227, 0xffff0000, v252
  v_mov_b32 v212, v224
  v_mov_b32 v213, v225
  v_mov_b32 v214, v226
  v_mov_b32 v215, v227
  v_mov_b32 v252, v224
  v_mov_b32 v253, v225
  v_mov_b32 v254, v226
  v_mov_b32 v255, v227
  v_permlane32_swap_b32 v212, v252
  v_permlane32_swap_b32 v213, v253
  v_permlane32_swap_b32 v214, v254
  v_permlane32_swap_b32 v215, v255
  v_mov_b32 v224, v212
  v_mov_b32 v212, v252
  v_mov_b32 v225, v213
  v_mov_b32 v213, v253
  v_mov_b32 v226, v214
  v_mov_b32 v214, v254
  v_mov_b32 v227, v215
  v_mov_b32 v215, v255
  v_lshlrev_b32 v216, 16, v228
  v_and_b32 v217, 0xffff0000, v228
  v_lshlrev_b32 v218, 16, v229
  v_and_b32 v219, 0xffff0000, v229
  s_cmp_ge_u32 s31, 0x200
  s_cbranch_scc1 L_vexit
  s_lshl_b32 s39, s29, 6
  s_sub_u32 s39, s39, 0x4000
  v_add_u32 v253, s39, v173
  ds_read_b32 v254, v253
  s_waitcnt vmcnt(18)
  s_waitcnt lgkmcnt(0)
  v_and_b32_dpp v244, v254, v4 row_newbcast:0 row_mask:0xf bank_mask:0xf
  v_and_b32_dpp v245, v254, v5 row_newbcast:0 row_mask:0xf bank_mask:0xf
  v_and_b32_dpp v246, v254, v6 row_newbcast:0 row_mask:0xf bank_mask:0xf
  v_and_b32_dpp v247, v254, v7 row_newbcast:0 row_mask:0xf bank_mask:0xf
  s_nop 1
  v_mfma_f32_16x16x32_bf16 v[240:243], v[244:247], v[96:99], v[240:243]
  v_and_b32_dpp v248, v254, v4 row_newbcast:4 row_mask:0xf bank_mask:0xf
  v_and_b32_dpp v249, v254, v5 row_newbcast:4 row_mask:0xf bank_mask:0xf
  v_and_b32_dpp v250, v254, v6 row_newbcast:4 row_mask:0xf bank_mask:0xf
  v_and_b32_dpp v251, v254, v7 row_newbcast:4 row_mask:0xf bank_mask:0xf
  s_nop 1
  v_mfma_f32_16x16x32_bf16 v[240:243], v[248:251], v[100:103], v[240:243]
  v_and_b32_dpp v244, v254, v4 row_newbcast:8 row_mask:0xf bank_mask:0xf
  v_and_b32_dpp v245, v254, v5 row_newbcast:8 row_mask:0xf bank_mask:0xf
  v_and_b32_dpp v246, v254, v6 row_newbcast:8 row_mask:0xf bank_mask:0xf
  v_and_b32_dpp v247, v254, v7 row_newbcast:8 row_mask:0xf bank_mask:0xf
  s_nop 1
  v_mfma_f32_16x16x32_bf16 v[240:243], v[244:247], v[104:107], v[240:243]
  v_and_b32_dpp v248, v254, v4 row_newbcast:12 row_mask:0xf bank_mask:0xf
  v_and_b32_dpp v249, v254, v5 row_newbcast:12 row_mask:0xf bank_mask:0xf
  v_and_b32_dpp v250, v254, v6 row_newbcast:12 row_mask:0xf bank_mask:0xf
  v_and_b32_dpp v251, v254, v7 row_newbcast:12 row_mask:0xf bank_mask:0xf
  s_nop 1
  v_mfma_f32_16x16x32_bf16 v[240:243], v[248:251], v[108:111], v[240:243]
  s_add_u32 s13, s97, 0
  buffer_load_dwordx4 v[96:99], v9, s[80:83], s13 offen
  s_add_u32 s13, s97, 3456
  buffer_load_dwordx4 v[100:103], v9, s[80:83], s13 offen
  s_add_u32 s13, s97, 6912
  buffer_load_dwordx4 v[104:107], v9, s[80:83], s13 offen
  s_add_u32 s13, s97, 10368
  buffer_load_dwordx4 v[108:111], v9, s[80:83], s13 offen
  s_lshl_b32 s39, s28, 6
  s_sub_u32 s39, s39, 0x4000
  v_add_u32 v253, s39, v173
  ds_read_b32 v254, v253
  s_waitcnt vmcnt(18)
  s_waitcnt lgkmcnt(0)
  v_and_b32_dpp v244, v254, v4 row_newbcast:0 row_mask:0xf bank_mask:0xf
  v_and_b32_dpp v245, v254, v5 row_newbcast:0 row_mask:0xf bank_mask:0xf
  v_and_b32_dpp v246, v254, v6 row_newbcast:0 row_mask:0xf bank_mask:0xf
  v_and_b32_dpp v247, v254, v7 row_newbcast:0 row_mask:0xf bank_mask:0xf
  s_nop 1
  v_mfma_f32_16x16x32_bf16 v[240:243], v[244:247], v[80:83], v[240:243]
  v_and_b32_dpp v248, v254, v4 row_newbcast:4 row_mask:0xf bank_mask:0xf
  v_and_b32_dpp v249, v254, v5 row_newbcast:4 row_mask:0xf bank_mask:0xf
  v_and_b32_dpp v250, v254, v6 row_newbcast:4 row_mask:0xf bank_mask:0xf
  v_and_b32_dpp v251, v254, v7 row_newbcast:4 row_mask:0xf bank_mask:0xf
  s_nop 1
  v_mfma_f32_16x16x32_bf16 v[240:243], v[248:251], v[84:87], v[240:243]
  v_and_b32_dpp v244, v254, v4 row_newbcast:8 row_mask:0xf bank_mask:0xf
  v_and_b32_dpp v245, v254, v5 row_newbcast:8 row_mask:0xf bank_mask:0xf
  v_and_b32_dpp v246, v254, v6 row_newbcast:8 row_mask:0xf bank_mask:0xf
  v_and_b32_dpp v247, v254, v7 row_newbcast:8 row_mask:0xf bank_mask:0xf
  s_nop 1
  v_mfma_f32_16x16x32_bf16 v[240:243], v[244:247], v[88:91], v[240:243]
  v_and_b32_dpp v248, v254, v4 row_newbcast:12 row_mask:0xf bank_mask:0xf
  v_and_b32_dpp v249, v254, v5 row_newbcast:12 row_mask:0xf bank_mask:0xf
  v_and_b32_dpp v250, v254, v6 row_newbcast:12 row_mask:0xf bank_mask:0xf
  v_and_b32_dpp v251, v254, v7 row_newbcast:12 row_mask:0xf bank_mask:0xf
  s_nop 1
  v_mfma_f32_16x16x32_bf16 v[240:243], v[248:251], v[92:95], v[240:243]
  s_add_u32 s13, s96, 4096
  buffer_load_dwordx4 v[80:83], v8, s[76:79], s13 offen
  s_add_u32 s13, s96, 4352
  buffer_load_dwordx4 v[84:87], v8, s[76:79], s13 offen
  s_add_u32 s13, s96, 4608
  buffer_load_dwordx4 v[88:91], v8, s[76:79], s13 offen
  s_add_u32 s13, s96, 4864
  buffer_load_dwordx4 v[92:95], v8, s[76:79], s13 offen
  s_mov_b32 exec_lo, 1
  s_mov_b32 exec_hi, 0
  ds_add_rtn_u32 v252, v174, v175 offset:8776
  s_mov_b32 exec_lo, -1
  s_mov_b32 exec_hi, -1
  s_lshl_b32 s39, s30, 6
  s_sub_u32 s39, s39, 0x4000
  v_add_u32 v253, s39, v173
  ds_read_b32 v254, v253
  s_waitcnt vmcnt(63)
  s_waitcnt lgkmcnt(0)
  v_and_b32_dpp v244, v254, v4 row_newbcast:0 row_mask:0xf bank_mask:0xf
  v_and_b32_dpp v245, v254, v5 row_newbcast:0 row_mask:0xf bank_mask:0xf
  v_and_b32_dpp v246, v254, v6 row_newbcast:0 row_mask:0xf bank_mask:0xf
  v_and_b32_dpp v247, v254, v7 row_newbcast:0 row_mask:0xf bank_mask:0xf
  s_nop 1
  v_mfma_f32_16x16x32_bf16 v[240:243], v[244:247], v[112:115], v[240:243]
  v_and_b32_dpp v248, v254, v4 row_newbcast:4 row_mask:0xf bank_mask:0xf
  v_and_b32_dpp v249, v254, v5 row_newbcast:4 row_mask:0xf bank_mask:0xf
  v_and_b32_dpp v250, v254, v6 row_newbcast:4 row_mask:0xf bank_mask:0xf
  v_and_b32_dpp v251, v254, v7 row_newbcast:4 row_mask:0xf bank_mask:0xf
  s_nop 1
  v_mfma_f32_16x16x32_bf16 v[240:243], v[248:251], v[116:119], v[240:243]
  v_and_b32_dpp v244, v254, v4 row_newbcast:8 row_mask:0xf bank_mask:0xf
  v_and_b32_dpp v245, v254, v5 row_newbcast:8 row_mask:0xf bank_mask:0xf
  v_and_b32_dpp v246, v254, v6 row_newbcast:8 row_mask:0xf bank_mask:0xf
  v_and_b32_dpp v247, v254, v7 row_newbcast:8 row_mask:0xf bank_mask:0xf
  s_nop 1
  v_mfma_f32_16x16x32_bf16 v[240:243], v[244:247], v[120:123], v[240:243]
  v_and_b32_dpp v248, v254, v4 row_newbcast:12 row_mask:0xf bank_mask:0xf
  v_and_b32_dpp v249, v254, v5 row_newbcast:12 row_mask:0xf bank_mask:0xf
  v_and_b32_dpp v250, v254, v6 row_newbcast:12 row_mask:0xf bank_mask:0xf
  v_and_b32_dpp v251, v254, v7 row_newbcast:12 row_mask:0xf bank_mask:0xf
  s_nop 1
  v_mfma_f32_16x16x32_bf16 v[240:243], v[248:251], v[124:127], v[240:243]
  v_readfirstlane_b32 s36, v252
  s_nop 3
  s_cmp_lt_u32 s36, 0x100
  s_cselect_b64 s[32:33], s[44:45], s[48:49]
  s_and_b32 s37, s36, 0xff
  s_lshl_b32 s37, s37, 12
  s_mov_b32 s30, s36
  s_cmp_ge_u32 s36, 0x200
  s_cbranch_scc1 L_vta6
  buffer_load_dwordx4 v[112:115], v2, s[32:35], s37 offen offset:0 nt
  buffer_load_dwordx4 v[116:119], v2, s[32:35], s37 offen offset:1024 nt
  buffer_load_dwordx4 v[120:123], v2, s[32:35], s37 offen offset:2048 nt
  buffer_load_dwordx4 v[124:127], v2, s[32:35], s37 offen offset:3072 nt
  s_branch L_vna6
L_vta6:
  s_nop 7
  s_add_u32 s13, s97, 13824
  buffer_load_dwordx4 v[112:115], v9, s[80:83], s13 offen
  s_add_u32 s13, s97, 17280
  buffer_load_dwordx4 v[116:119], v9, s[80:83], s13 offen
  s_add_u32 s13, s97, 20736
  buffer_load_dwordx4 v[120:123], v9, s[80:83], s13 offen
  s_add_u32 s13, s97, 24192
  buffer_load_dwordx4 v[124:127], v9, s[80:83], s13 offen
L_vna6:
  s_nop 7
  s_mov_b32 exec_lo, 1
  s_mov_b32 exec_hi, 0
  ds_add_rtn_u32 v252, v174, v175 offset:8776
  s_mov_b32 exec_lo, -1
  s_mov_b32 exec_hi, -1
  s_lshl_b32 s39, s31, 6
  s_sub_u32 s39, s39, 0x4000
  v_add_u32 v253, s39, v173
  ds_read_b32 v254, v253
  s_waitcnt vmcnt(63)
  s_waitcnt lgkmcnt(0)
  v_and_b32_dpp v244, v254, v4 row_newbcast:0 row_mask:0xf bank_mask:0xf
  v_and_b32_dpp v245, v254, v5 row_newbcast:0 row_mask:0xf bank_mask:0xf
  v_and_b32_dpp v246, v254, v6 row_newbcast:0 row_mask:0xf bank_mask:0xf
  v_and_b32_dpp v247, v254, v7 row_newbcast:0 row_mask:0xf bank_mask:0xf
  s_nop 1
  v_mfma_f32_16x16x32_bf16 v[240:243], v[244:247], v[128:131], v[240:243]
  v_and_b32_dpp v248, v254, v4 row_newbcast:4 row_mask:0xf bank_mask:0xf
  v_and_b32_dpp v249, v254, v5 row_newbcast:4 row_mask:0xf bank_mask:0xf
  v_and_b32_dpp v250, v254, v6 row_newbcast:4 row_mask:0xf bank_mask:0xf
  v_and_b32_dpp v251, v254, v7 row_newbcast:4 row_mask:0xf bank_mask:0xf
  s_nop 1
  v_mfma_f32_16x16x32_bf16 v[240:243], v[248:251], v[132:135], v[240:243]
  v_and_b32_dpp v244, v254, v4 row_newbcast:8 row_mask:0xf bank_mask:0xf
  v_and_b32_dpp v245, v254, v5 row_newbcast:8 row_mask:0xf bank_mask:0xf
  v_and_b32_dpp v246, v254, v6 row_newbcast:8 row_mask:0xf bank_mask:0xf
  v_and_b32_dpp v247, v254, v7 row_newbcast:8 row_mask:0xf bank_mask:0xf
  s_nop 1
  v_mfma_f32_16x16x32_bf16 v[240:243], v[244:247], v[136:139], v[240:243]
  v_and_b32_dpp v248, v254, v4 row_newbcast:12 row_mask:0xf bank_mask:0xf
  v_and_b32_dpp v249, v254, v5 row_newbcast:12 row_mask:0xf bank_mask:0xf
  v_and_b32_dpp v250, v254, v6 row_newbcast:12 row_mask:0xf bank_mask:0xf
  v_and_b32_dpp v251, v254, v7 row_newbcast:12 row_mask:0xf bank_mask:0xf
  s_nop 1
  v_mfma_f32_16x16x32_bf16 v[240:243], v[248:251], v[140:143], v[240:243]
  v_readfirstlane_b32 s36, v252
  s_nop 3
  s_cmp_lt_u32 s36, 0x100
  s_cselect_b64 s[32:33], s[44:45], s[48:49]
  s_and_b32 s37, s36, 0xff
  s_lshl_b32 s37, s37, 12
  s_mov_b32 s31, s36
  s_cmp_ge_u32 s36, 0x200
  s_cbranch_scc1 L_vta7
  buffer_load_dwordx4 v[128:131], v2, s[32:35], s37 offen offset:0 nt
  buffer_load_dwordx4 v[132:135], v2, s[32:35], s37 offen offset:1024 nt
  buffer_load_dwordx4 v[136:139], v2, s[32:35], s37 offen offset:2048 nt
  buffer_load_dwordx4 v[140:143], v2, s[32:35], s37 offen offset:3072 nt
  s_branch L_vna7
L_vta7:
  s_nop 7
  s_add_u32 s13, s97, 27648
  buffer_load_dwordx4 v[128:131], v9, s[80:83], s13 offen
  s_add_u32 s13, s97, 31104
  buffer_load_dwordx4 v[132:135], v9, s[80:83], s13 offen
  s_add_u32 s13, s98, 0
  buffer_load_dwordx4 v[136:139], v12, s[84:87], s13 offen
  s_add_u32 s13, s98, 256
  buffer_load_dwordx4 v[140:143], v12, s[84:87], s13 offen
L_vna7:
  s_nop 7
L_vloop:
  s_nop 7
  s_cmp_ge_u32 s30, 0x200
  s_cbranch_scc1 L_vexit
  s_mov_b32 exec_lo, 1
  s_mov_b32 exec_hi, 0
  ds_add_rtn_u32 v252, v174, v175 offset:8776
  s_mov_b32 exec_lo, -1
  s_mov_b32 exec_hi, -1
  s_lshl_b32 s39, s30, 6
  s_sub_u32 s39, s39, 0x4000
  v_add_u32 v253, s39, v173
  ds_read_b32 v254, v253
  s_waitcnt vmcnt(4)
  s_waitcnt lgkmcnt(0)
  v_and_b32_dpp v244, v254, v4 row_newbcast:0 row_mask:0xf bank_mask:0xf
  v_and_b32_dpp v245, v254, v5 row_newbcast:0 row_mask:0xf bank_mask:0xf
  v_and_b32_dpp v246, v254, v6 row_newbcast:0 row_mask:0xf bank_mask:0xf
  v_and_b32_dpp v247, v254, v7 row_newbcast:0 row_mask:0xf bank_mask:0xf
  s_nop 1
  v_mfma_f32_16x16x32_bf16 v[240:243], v[244:247], v[112:115], v[240:243]
  v_and_b32_dpp v248, v254, v4 row_newbcast:4 row_mask:0xf bank_mask:0xf
  v_and_b32_dpp v249, v254, v5 row_newbcast:4 row_mask:0xf bank_mask:0xf
  v_and_b32_dpp v250, v254, v6 row_newbcast:4 row_mask:0xf bank_mask:0xf
  v_and_b32_dpp v251, v254, v7 row_newbcast:4 row_mask:0xf bank_mask:0xf
  s_nop 1
  v_mfma_f32_16x16x32_bf16 v[240:243], v[248:251], v[116:119], v[240:243]
  v_and_b32_dpp v244, v254, v4 row_newbcast:8 row_mask:0xf bank_mask:0xf
  v_and_b32_dpp v245, v254, v5 row_newbcast:8 row_mask:0xf bank_mask:0xf
  v_and_b32_dpp v246, v254, v6 row_newbcast:8 row_mask:0xf bank_mask:0xf
  v_and_b32_dpp v247, v254, v7 row_newbcast:8 row_mask:0xf bank_mask:0xf
  s_nop 1
  v_mfma_f32_16x16x32_bf16 v[240:243], v[244:247], v[120:123], v[240:243]
  v_and_b32_dpp v248, v254, v4 row_newbcast:12 row_mask:0xf bank_mask:0xf
  v_and_b32_dpp v249, v254, v5 row_newbcast:12 row_mask:0xf bank_mask:0xf
  v_and_b32_dpp v250, v254, v6 row_newbcast:12 row_mask:0xf bank_mask:0xf
  v_and_b32_dpp v251, v254, v7 row_newbcast:12 row_mask:0xf bank_mask:0xf
  s_nop 1
  v_mfma_f32_16x16x32_bf16 v[240:243], v[248:251], v[124:127], v[240:243]
  v_readfirstlane_b32 s36, v252
  s_nop 3
  s_cmp_lt_u32 s36, 0x100
  s_cselect_b64 s[32:33], s[44:45], s[48:49]
  s_and_b32 s37, s36, 0xff
  s_lshl_b32 s37, s37, 12
  s_mov_b32 s30, s36
  s_cmp_ge_u32 s36, 0x200
  s_cbranch_scc1 L_vtb6
  buffer_load_dwordx4 v[112:115], v2, s[32:35], s37 offen offset:0 nt
  buffer_load_dwordx4 v[116:119], v2, s[32:35], s37 offen offset:1024 nt
  buffer_load_dwordx4 v[120:123], v2, s[32:35], s37 offen offset:2048 nt
  buffer_load_dwordx4 v[124:127], v2, s[32:35], s37 offen offset:3072 nt
  s_branch L_vnb6
L_vtb6:
  s_nop 7
  s_add_u32 s13, s97, 13824
  buffer_load_dwordx4 v[112:115], v9, s[80:83], s13 offen
  s_add_u32 s13, s97, 17280
  buffer_load_dwordx4 v[116:119], v9, s[80:83], s13 offen
  s_add_u32 s13, s97, 20736
  buffer_load_dwordx4 v[120:123], v9, s[80:83], s13 offen
  s_add_u32 s13, s97, 24192
  buffer_load_dwordx4 v[124:127], v9, s[80:83], s13 offen
L_vnb6:
  s_nop 7
  s_cmp_ge_u32 s31, 0x200
  s_cbranch_scc1 L_vexit
  s_mov_b32 exec_lo, 1
  s_mov_b32 exec_hi, 0
  ds_add_rtn_u32 v252, v174, v175 offset:8776
  s_mov_b32 exec_lo, -1
  s_mov_b32 exec_hi, -1
  s_lshl_b32 s39, s31, 6
  s_sub_u32 s39, s39, 0x4000
  v_add_u32 v253, s39, v173
  ds_read_b32 v254, v253
  s_waitcnt vmcnt(4)
  s_waitcnt lgkmcnt(0)
  v_and_b32_dpp v244, v254, v4 row_newbcast:0 row_mask:0xf bank_mask:0xf
  v_and_b32_dpp v245, v254, v5 row_newbcast:0 row_mask:0xf bank_mask:0xf
  v_and_b32_dpp v246, v254, v6 row_newbcast:0 row_mask:0xf bank_mask:0xf
  v_and_b32_dpp v247, v254, v7 row_newbcast:0 row_mask:0xf bank_mask:0xf
  s_nop 1
  v_mfma_f32_16x16x32_bf16 v[240:243], v[244:247], v[128:131], v[240:243]
  v_and_b32_dpp v248, v254, v4 row_newbcast:4 row_mask:0xf bank_mask:0xf
  v_and_b32_dpp v249, v254, v5 row_newbcast:4 row_mask:0xf bank_mask:0xf
  v_and_b32_dpp v250, v254, v6 row_newbcast:4 row_mask:0xf bank_mask:0xf
  v_and_b32_dpp v251, v254, v7 row_newbcast:4 row_mask:0xf bank_mask:0xf
  s_nop 1
  v_mfma_f32_16x16x32_bf16 v[240:243], v[248:251], v[132:135], v[240:243]
  v_and_b32_dpp v244, v254, v4 row_newbcast:8 row_mask:0xf bank_mask:0xf
  v_and_b32_dpp v245, v254, v5 row_newbcast:8 row_mask:0xf bank_mask:0xf
  v_and_b32_dpp v246, v254, v6 row_newbcast:8 row_mask:0xf bank_mask:0xf
  v_and_b32_dpp v247, v254, v7 row_newbcast:8 row_mask:0xf bank_mask:0xf
  s_nop 1
  v_mfma_f32_16x16x32_bf16 v[240:243], v[244:247], v[136:139], v[240:243]
  v_and_b32_dpp v248, v254, v4 row_newbcast:12 row_mask:0xf bank_mask:0xf
  v_and_b32_dpp v249, v254, v5 row_newbcast:12 row_mask:0xf bank_mask:0xf
  v_and_b32_dpp v250, v254, v6 row_newbcast:12 row_mask:0xf bank_mask:0xf
  v_and_b32_dpp v251, v254, v7 row_newbcast:12 row_mask:0xf bank_mask:0xf
  s_nop 1
  v_mfma_f32_16x16x32_bf16 v[240:243], v[248:251], v[140:143], v[240:243]
  v_readfirstlane_b32 s36, v252
  s_nop 3
  s_cmp_lt_u32 s36, 0x100
  s_cselect_b64 s[32:33], s[44:45], s[48:49]
  s_and_b32 s37, s36, 0xff
  s_lshl_b32 s37, s37, 12
  s_mov_b32 s31, s36
  s_cmp_ge_u32 s36, 0x200
  s_cbranch_scc1 L_vtb7
  buffer_load_dwordx4 v[128:131], v2, s[32:35], s37 offen offset:0 nt
  buffer_load_dwordx4 v[132:135], v2, s[32:35], s37 offen offset:1024 nt
  buffer_load_dwordx4 v[136:139], v2, s[32:35], s37 offen offset:2048 nt
  buffer_load_dwordx4 v[140:143], v2, s[32:35], s37 offen offset:3072 nt
  s_branch L_vnb7
L_vtb7:
  s_nop 7
  s_add_u32 s13, s97, 27648
  buffer_load_dwordx4 v[128:131], v9, s[80:83], s13 offen
  s_add_u32 s13, s97, 31104
  buffer_load_dwordx4 v[132:135], v9, s[80:83], s13 offen
  s_add_u32 s13, s98, 0
  buffer_load_dwordx4 v[136:139], v12, s[84:87], s13 offen
  s_add_u32 s13, s98, 256
  buffer_load_dwordx4 v[140:143], v12, s[84:87], s13 offen
L_vnb7:
  s_nop 7
  s_branch L_vloop
L_vexit:
  s_nop 7
  s_lshl_b32 s10, s3, 9
  v_add_u32 v13, s10, v14
  s_mov_b32 exec_lo, -1
  s_mov_b32 exec_hi, 0
  ds_write_b128 v13, v[240:243] offset:9216
  s_mov_b32 exec_lo, -1
  s_mov_b32 exec_hi, -1
  s_waitcnt lgkmcnt(0)
  s_barrier
  s_lshl_b32 s10, s3, 6
  v_lshlrev_b32 v13, 4, v11
  v_add_u32 v13, s10, v13
  ds_read_b128 v[144:147], v13 offset:9216
  ds_read_b128 v[148:151], v13 offset:9728
  ds_read_b128 v[152:155], v13 offset:10240
  ds_read_b128 v[156:159], v13 offset:10752
  ds_read_b128 v[160:163], v13 offset:11264
  ds_read_b128 v[164:167], v13 offset:11776
  ds_read_b128 v[168:171], v13 offset:12288
  ds_read_b128 v[172:175], v13 offset:12800
  s_waitcnt lgkmcnt(0)
  v_add_f32 v144, v144, v148
  v_add_f32 v145, v145, v149
  v_add_f32 v146, v146, v150
  v_add_f32 v147, v147, v151
  v_add_f32 v144, v144, v152
  v_add_f32 v145, v145, v153
  v_add_f32 v146, v146, v154
  v_add_f32 v147, v147, v155
  v_add_f32 v144, v144, v156
  v_add_f32 v145, v145, v157
  v_add_f32 v146, v146, v158
  v_add_f32 v147, v147, v159
  v_add_f32 v144, v144, v160
  v_add_f32 v145, v145, v161
  v_add_f32 v146, v146, v162
  v_add_f32 v147, v147, v163
  v_add_f32 v144, v144, v164
  v_add_f32 v145, v145, v165
  v_add_f32 v146, v146, v166
  v_add_f32 v147, v147, v167
  v_add_f32 v144, v144, v168
  v_add_f32 v145, v145, v169
  v_add_f32 v146, v146, v170
  v_add_f32 v147, v147, v171
  v_add_f32 v144, v144, v172
  v_add_f32 v145, v145, v173
  v_add_f32 v146, v146, v174
  v_add_f32 v147, v147, v175
  v_cvt_pk_bf16_f32 v144, v144, v144
  v_cvt_pk_bf16_f32 v145, v145, v145
  v_cvt_pk_bf16_f32 v146, v146, v146
  v_cvt_pk_bf16_f32 v147, v147, v147
  v_mov_b32 v152, 0
  v_mov_b32 v153, 0
  v_mov_b32 v154, 0
  v_mov_b32 v155, 0
  v_mov_b32 v156, 0
  v_mov_b32 v157, 0
  v_mov_b32 v158, 0
  v_mov_b32 v159, 0
  v_mov_b32 v160, 0
  v_mov_b32 v161, 0
  v_mov_b32 v162, 0
  v_mov_b32 v163, 0
  v_mov_b32 v164, 0
  v_mov_b32 v165, 0
  v_mov_b32 v166, 0
  v_mov_b32 v167, 0
  v_mov_b32 v168, 0
  v_mov_b32 v169, 0
  v_mov_b32 v170, 0
  v_mov_b32 v171, 0
  s_waitcnt vmcnt(8)
  v_and_b32 v244, v144, v4
  v_and_b32 v245, v144, v5
  v_and_b32 v246, v144, v6
  v_and_b32 v247, v144, v7
  s_nop 1
  v_mfma_f32_16x16x32_bf16 v[152:155], v[244:247], v[16:19], v[152:155]
  v_and_b32 v248, v144, v4
  v_and_b32 v249, v144, v5
  v_and_b32 v250, v144, v6
  v_and_b32 v251, v144, v7
  s_nop 1
  v_mfma_f32_16x16x32_bf16 v[156:159], v[248:251], v[20:23], v[156:159]
  v_and_b32 v244, v144, v4
  v_and_b32 v245, v144, v5
  v_and_b32 v246, v144, v6
  v_and_b32 v247, v144, v7
  s_nop 1
  v_mfma_f32_16x16x32_bf16 v[160:163], v[244:247], v[24:27], v[160:163]
  v_and_b32 v248, v144, v4
  v_and_b32 v249, v144, v5
  v_and_b32 v250, v144, v6
  v_and_b32 v251, v144, v7
  s_nop 1
  v_mfma_f32_16x16x32_bf16 v[164:167], v[248:251], v[28:31], v[164:167]
  v_and_b32 v244, v144, v4
  v_and_b32 v245, v144, v5
  v_and_b32 v246, v144, v6
  v_and_b32 v247, v144, v7
  s_nop 1
  v_mfma_f32_16x16x32_bf16 v[168:171], v[244:247], v[32:35], v[168:171]
  v_and_b32 v248, v145, v4
  v_and_b32 v249, v145, v5
  v_and_b32 v250, v145, v6
  v_and_b32 v251, v145, v7
  s_nop 1
  v_mfma_f32_16x16x32_bf16 v[152:155], v[248:251], v[36:39], v[152:155]
  v_and_b32 v244, v145, v4
  v_and_b32 v245, v145, v5
  v_and_b32 v246, v145, v6
  v_and_b32 v247, v145, v7
  s_nop 1
  v_mfma_f32_16x16x32_bf16 v[156:159], v[244:247], v[40:43], v[156:159]
  v_and_b32 v248, v145, v4
  v_and_b32 v249, v145, v5
  v_and_b32 v250, v145, v6
  v_and_b32 v251, v145, v7
  s_nop 1
  v_mfma_f32_16x16x32_bf16 v[160:163], v[248:251], v[44:47], v[160:163]
  v_and_b32 v244, v145, v4
  v_and_b32 v245, v145, v5
  v_and_b32 v246, v145, v6
  v_and_b32 v247, v145, v7
  s_nop 1
  v_mfma_f32_16x16x32_bf16 v[164:167], v[244:247], v[48:51], v[164:167]
  v_and_b32 v248, v145, v4
  v_and_b32 v249, v145, v5
  v_and_b32 v250, v145, v6
  v_and_b32 v251, v145, v7
  s_nop 1
  v_mfma_f32_16x16x32_bf16 v[168:171], v[248:251], v[52:55], v[168:171]
  v_and_b32 v244, v146, v4
  v_and_b32 v245, v146, v5
  v_and_b32 v246, v146, v6
  v_and_b32 v247, v146, v7
  s_nop 1
  v_mfma_f32_16x16x32_bf16 v[152:155], v[244:247], v[56:59], v[152:155]
  v_and_b32 v248, v146, v4
  v_and_b32 v249, v146, v5
  v_and_b32 v250, v146, v6
  v_and_b32 v251, v146, v7
  s_nop 1
  v_mfma_f32_16x16x32_bf16 v[156:159], v[248:251], v[60:63], v[156:159]
  v_and_b32 v244, v146, v4
  v_and_b32 v245, v146, v5
  v_and_b32 v246, v146, v6
  v_and_b32 v247, v146, v7
  s_nop 1
  v_mfma_f32_16x16x32_bf16 v[160:163], v[244:247], v[64:67], v[160:163]
  v_and_b32 v248, v146, v4
  v_and_b32 v249, v146, v5
  v_and_b32 v250, v146, v6
  v_and_b32 v251, v146, v7
  s_nop 1
  v_mfma_f32_16x16x32_bf16 v[164:167], v[248:251], v[68:71], v[164:167]
  v_and_b32 v244, v146, v4
  v_and_b32 v245, v146, v5
  v_and_b32 v246, v146, v6
  v_and_b32 v247, v146, v7
  s_nop 1
  v_mfma_f32_16x16x32_bf16 v[168:171], v[244:247], v[72:75], v[168:171]
  v_and_b32 v248, v147, v4
  v_and_b32 v249, v147, v5
  v_and_b32 v250, v147, v6
  v_and_b32 v251, v147, v7
  s_nop 1
  v_mfma_f32_16x16x32_bf16 v[152:155], v[248:251], v[76:79], v[152:155]
  v_and_b32 v244, v147, v4
  v_and_b32 v245, v147, v5
  v_and_b32 v246, v147, v6
  v_and_b32 v247, v147, v7
  s_nop 1
  v_mfma_f32_16x16x32_bf16 v[156:159], v[244:247], v[80:83], v[156:159]
  v_and_b32 v248, v147, v4
  v_and_b32 v249, v147, v5
  v_and_b32 v250, v147, v6
  v_and_b32 v251, v147, v7
  s_nop 1
  v_mfma_f32_16x16x32_bf16 v[160:163], v[248:251], v[84:87], v[160:163]
  v_and_b32 v244, v147, v4
  v_and_b32 v245, v147, v5
  v_and_b32 v246, v147, v6
  v_and_b32 v247, v147, v7
  s_nop 1
  v_mfma_f32_16x16x32_bf16 v[164:167], v[244:247], v[88:91], v[164:167]
  v_and_b32 v248, v147, v4
  v_and_b32 v249, v147, v5
  v_and_b32 v250, v147, v6
  v_and_b32 v251, v147, v7
  s_nop 1
  v_mfma_f32_16x16x32_bf16 v[168:171], v[248:251], v[92:95], v[168:171]
  s_mul_i32 s10, s3, 2560
  v_add_u32 v13, s10, v14
  s_mov_b32 exec_lo, -1
  s_mov_b32 exec_hi, 0
  ds_write_b128 v13, v[152:155] offset:24576
  ds_write_b128 v13, v[156:159] offset:25088
  ds_write_b128 v13, v[160:163] offset:25600
  ds_write_b128 v13, v[164:167] offset:26112
  ds_write_b128 v13, v[168:171] offset:26624
  s_mov_b32 exec_lo, -1
  s_mov_b32 exec_hi, -1
  s_waitcnt lgkmcnt(0)
  s_barrier
  s_mul_i32 s10, s4, 81920
  s_lshl_b32 s11, s5, 7
  s_add_u32 s10, s10, s11
  s_add_u32 s15, s10, 524288
  s_add_u32 s42, s10, 1212416
  s_mul_i32 s10, s4, 2560
  s_add_u32 s10, s10, s11
  s_add_u32 s43, s10, 1179648
  s_cmp_ge_u32 s3, 3
  s_cbranch_scc1 L_t1a
  v_lshlrev_b32 v13, 4, v0
  ds_read_b128 v[144:147], v13 offset:24576
  ds_read_b128 v[148:151], v13 offset:27136
  ds_read_b128 v[152:155], v13 offset:29696
  ds_read_b128 v[156:159], v13 offset:32256
  ds_read_b128 v[160:163], v13 offset:34816
  ds_read_b128 v[164:167], v13 offset:37376
  ds_read_b128 v[168:171], v13 offset:39936
  ds_read_b128 v[172:175], v13 offset:42496
  s_waitcnt lgkmcnt(0)
  v_add_f32 v144, v144, v148
  v_add_f32 v145, v145, v149
  v_add_f32 v146, v146, v150
  v_add_f32 v147, v147, v151
  v_add_f32 v144, v144, v152
  v_add_f32 v145, v145, v153
  v_add_f32 v146, v146, v154
  v_add_f32 v147, v147, v155
  v_add_f32 v144, v144, v156
  v_add_f32 v145, v145, v157
  v_add_f32 v146, v146, v158
  v_add_f32 v147, v147, v159
  v_add_f32 v144, v144, v160
  v_add_f32 v145, v145, v161
  v_add_f32 v146, v146, v162
  v_add_f32 v147, v147, v163
  v_add_f32 v144, v144, v164
  v_add_f32 v145, v145, v165
  v_add_f32 v146, v146, v166
  v_add_f32 v147, v147, v167
  v_add_f32 v144, v144, v168
  v_add_f32 v145, v145, v169
  v_add_f32 v146, v146, v170
  v_add_f32 v147, v147, v171
  v_add_f32 v144, v144, v172
  v_add_f32 v145, v145, v173
  v_add_f32 v146, v146, v174
  v_add_f32 v147, v147, v175
  v_min_u32 v144, 0xfffffffe, v144
  v_min_u32 v145, 0xfffffffe, v145
  v_min_u32 v146, 0xfffffffe, v146
  v_min_u32 v147, 0xfffffffe, v147
  v_lshrrev_b32 v13, 3, v0
  v_lshlrev_b32 v13, 12, v13
  v_and_b32 v15, 7, v0
  v_lshl_add_u32 v13, v15, 4, v13
  v_mov_b32 v15, 0x7fffffff
  v_cmp_gt_u32 vcc, 160, v0
  s_nop 1
  v_cndmask_b32 v13, v15, v13, vcc
  buffer_store_dwordx4 v[144:147], v13, s[60:63], s15 offen sc1
L_t1a:
  s_nop 7
  s_cmp_ge_u32 s5, 27
  s_cbranch_scc1 L_end
  s_cmp_lg_u32 s3, 0
  s_cbranch_scc1 L_t3_wait
  s_cmp_ge_u32 s5, 20
  s_cbranch_scc1 L_t2_skip
  s_mul_i32 s10, s4, 20
  s_add_u32 s10, s10, s5
  s_lshl_b32 s10, s10, 12
  s_add_u32 s10, s10, 524288
  v_lshlrev_b32 v13, 4, v1
  v_mov_b32 v15, 0x7fffffff
  v_add_u32 v12, 3072, v13
  v_cmp_gt_u32 vcc, 64, v1
  s_nop 1
  v_cndmask_b32 v12, v15, v12, vcc
  s_mov_b32 s95, 0
L_g1:
  s_nop 7
  buffer_load_dwordx4 v[16:19], v13, s[60:63], s10 offen offset:0 sc1
  buffer_load_dwordx4 v[20:23], v13, s[60:63], s10 offen offset:1024 sc1
  buffer_load_dwordx4 v[24:27], v13, s[60:63], s10 offen offset:2048 sc1
  buffer_load_dwordx4 v[28:31], v12, s[60:63], s10 offen sc1
  s_waitcnt vmcnt(0)
  v_max3_u32 v252, v16, v17, v18
  v_max3_u32 v252, v252, v19, v20
  v_max3_u32 v252, v252, v21, v22
  v_max3_u32 v252, v252, v23, v24
  v_max3_u32 v252, v252, v25, v26
  v_max3_u32 v252, v252, v27, v28
  v_max3_u32 v252, v252, v29, v30
  v_max_u32 v252, v252, v31
  v_cmp_eq_u32 vcc, -1, v252
  s_cbranch_vccz L_g1_done
  s_add_u32 s95, s95, 1
  s_cmp_lt_u32 s95, 200000
  s_cbranch_scc1 L_g1
L_g1_done:
  s_nop 7
  v_add_f32 v16, v16, v20
  v_add_f32 v24, v24, v28
  v_add_f32 v16, v16, v24
  v_add_f32 v17, v17, v21
  v_add_f32 v25, v25, v29
  v_add_f32 v17, v17, v25
  v_add_f32 v18, v18, v22
  v_add_f32 v26, v26, v30
  v_add_f32 v18, v18, v26
  v_add_f32 v19, v19, v23
  v_add_f32 v27, v27, v31
  v_add_f32 v19, v19, v27
  v_add_f32_dpp v16, v16, v16 row_ror:8 row_mask:0xf bank_mask:0xf
  v_add_f32_dpp v17, v17, v17 row_ror:8 row_mask:0xf bank_mask:0xf
  v_add_f32_dpp v18, v18, v18 row_ror:8 row_mask:0xf bank_mask:0xf
  v_add_f32_dpp v19, v19, v19 row_ror:8 row_mask:0xf bank_mask:0xf
  v_mov_b32 v252, v16
  v_mov_b32 v253, v17
  v_mov_b32 v254, v18
  v_mov_b32 v255, v19
  v_permlane16_swap_b32 v16, v252
  v_permlane16_swap_b32 v17, v253
  v_permlane16_swap_b32 v18, v254
  v_permlane16_swap_b32 v19, v255
  v_add_f32 v16, v16, v252
  v_add_f32 v17, v17, v253
  v_add_f32 v18, v18, v254
  v_add_f32 v19, v19, v255
  v_mov_b32 v252, v16
  v_mov_b32 v253, v17
  v_mov_b32 v254, v18
  v_mov_b32 v255, v19
  v_permlane32_swap_b32 v16, v252
  v_permlane32_swap_b32 v17, v253
  v_permlane32_swap_b32 v18, v254
  v_permlane32_swap_b32 v19, v255
  v_add_f32 v16, v16, v252
  v_add_f32 v17, v17, v253
  v_add_f32 v18, v18, v254
  v_add_f32 v19, v19, v255
  v_cvt_pk_bf16_f32 v252, v16, v17
  v_lshlrev_b32 v16, 16, v252
  v_and_b32 v17, 0xffff0000, v252
  v_cvt_pk_bf16_f32 v252, v18, v19
  v_lshlrev_b32 v18, 16, v252
  v_and_b32 v19, 0xffff0000, v252
  v_mul_f32 v16, v16, v224
  v_mul_f32 v17, v17, v225
  v_mul_f32 v18, v18, v226
  v_mul_f32 v19, v19, v227
  v_cvt_pk_bf16_f32 v252, v16, v17
  v_lshlrev_b32 v16, 16, v252
  v_and_b32 v17, 0xffff0000, v252
  v_cvt_pk_bf16_f32 v252, v18, v19
  v_lshlrev_b32 v18, 16, v252
  v_and_b32 v19, 0xffff0000, v252
  v_add_f32 v216, v216, v16
  v_add_f32 v217, v217, v17
  v_add_f32 v218, v218, v18
  v_add_f32 v219, v219, v19
  v_cvt_pk_bf16_f32 v252, v216, v217
  v_lshlrev_b32 v216, 16, v252
  v_and_b32 v217, 0xffff0000, v252
  v_cvt_pk_bf16_f32 v252, v218, v219
  v_lshlrev_b32 v218, 16, v252
  v_and_b32 v219, 0xffff0000, v252
  v_min_u32 v216, 0xfffffffe, v216
  v_min_u32 v217, 0xfffffffe, v217
  v_min_u32 v218, 0xfffffffe, v218
  v_min_u32 v219, 0xfffffffe, v219
  v_lshlrev_b32 v13, 4, v1
  s_mov_b32 exec_lo, 0xff
  s_mov_b32 exec_hi, 0
  buffer_store_dwordx4 v[216:219], v13, s[60:63], s43 offen sc1
  s_mov_b32 exec_lo, -1
  s_mov_b32 exec_hi, -1
L_t2_skip:
  s_nop 7
  v_lshlrev_b32 v12, 4, v1
  v_cmp_gt_u32 vcc, 32, v1
  v_mov_b32 v15, 0x7fffffff
  v_add_u32 v13, 2048, v12
  v_cndmask_b32 v13, v15, v13, vcc
  s_mul_i32 s10, s4, 2560
  s_add_u32 s10, s10, 1179648
  s_mov_b32 s95, 0
L_g2:
  s_nop 7
  buffer_load_dwordx4 v[32:35], v12, s[60:63], s10 offen sc1
  buffer_load_dwordx4 v[36:39], v12, s[60:63], s10 offen offset:1024 sc1
  buffer_load_dwordx4 v[40:43], v13, s[60:63], s10 offen sc1
  s_waitcnt vmcnt(0)
  v_max3_u32 v252, v32, v33, v34
  v_max3_u32 v252, v252, v35, v36
  v_max3_u32 v252, v252, v37, v38
  v_max3_u32 v252, v252, v39, v40
  v_max3_u32 v252, v252, v41, v42
  v_max_u32 v252, v252, v43
  v_cmp_eq_u32 vcc, -1, v252
  s_cbranch_vccz L_g2_done
  s_add_u32 s95, s95, 1
  s_cmp_lt_u32 s95, 200000
  s_cbranch_scc1 L_g2
L_g2_done:
  s_nop 7
  v_add_f32 v48, v32, v33
  v_add_f32 v48, v48, v34
  v_add_f32 v48, v48, v35
  v_add_f32 v48, v48, v36
  v_add_f32 v48, v48, v37
  v_add_f32 v48, v48, v38
  v_add_f32 v48, v48, v39
  v_add_f32 v48, v48, v40
  v_add_f32 v48, v48, v41
  v_add_f32 v48, v48, v42
  v_add_f32 v48, v48, v43
  s_nop 1
  v_add_f32_dpp v48, v48, v48 quad_perm:[1,0,3,2] row_mask:0xf bank_mask:0xf
  s_nop 1
  v_add_f32_dpp v48, v48, v48 quad_perm:[2,3,0,1] row_mask:0xf bank_mask:0xf
  s_nop 1
  v_add_f32_dpp v48, v48, v48 row_ror:4 row_mask:0xf bank_mask:0xf
  s_nop 1
  v_add_f32_dpp v48, v48, v48 row_ror:8 row_mask:0xf bank_mask:0xf
  v_mov_b32 v49, v48
  s_nop 1
  v_permlane16_swap_b32 v48, v49
  v_add_f32 v48, v48, v49
  v_mov_b32 v49, v48
  s_nop 1
  v_permlane32_swap_b32 v48, v49
  v_add_f32 v48, v48, v49
  v_mul_f32 v50, 0x3acccccd, v48
  v_sub_f32 v52, v32, v50
  v_sub_f32 v53, v33, v50
  v_sub_f32 v54, v34, v50
  v_sub_f32 v55, v35, v50
  v_sub_f32 v56, v36, v50
  v_sub_f32 v57, v37, v50
  v_sub_f32 v58, v38, v50
  v_sub_f32 v59, v39, v50
  v_sub_f32 v60, v40, v50
  v_sub_f32 v61, v41, v50
  v_sub_f32 v62, v42, v50
  v_sub_f32 v63, v43, v50
  v_cmp_gt_u32 vcc, 32, v1
  s_nop 1
  v_cndmask_b32 v60, 0, v60, vcc
  v_cndmask_b32 v61, 0, v61, vcc
  v_cndmask_b32 v62, 0, v62, vcc
  v_cndmask_b32 v63, 0, v63, vcc
  v_mul_f32 v48, v52, v52
  v_fmac_f32 v48, v53, v53
  v_fmac_f32 v48, v54, v54
  v_fmac_f32 v48, v55, v55
  v_fmac_f32 v48, v56, v56
  v_fmac_f32 v48, v57, v57
  v_fmac_f32 v48, v58, v58
  v_fmac_f32 v48, v59, v59
  v_fmac_f32 v48, v60, v60
  v_fmac_f32 v48, v61, v61
  v_fmac_f32 v48, v62, v62
  v_fmac_f32 v48, v63, v63
  s_nop 1
  v_add_f32_dpp v48, v48, v48 quad_perm:[1,0,3,2] row_mask:0xf bank_mask:0xf
  s_nop 1
  v_add_f32_dpp v48, v48, v48 quad_perm:[2,3,0,1] row_mask:0xf bank_mask:0xf
  s_nop 1
  v_add_f32_dpp v48, v48, v48 row_ror:4 row_mask:0xf bank_mask:0xf
  s_nop 1
  v_add_f32_dpp v48, v48, v48 row_ror:8 row_mask:0xf bank_mask:0xf
  v_mov_b32 v49, v48
  s_nop 1
  v_permlane16_swap_b32 v48, v49
  v_add_f32 v48, v48, v49
  v_mov_b32 v49, v48
  s_nop 1
  v_permlane32_swap_b32 v48, v49
  v_add_f32 v48, v48, v49
  v_mul_f32 v51, 0x3acccccd, v48
  v_cvt_pk_bf16_f32 v49, v50, v51
  v_lshlrev_b32 v50, 16, v49
  v_and_b32 v51, 0xffff0000, v49
  v_add_f32 v51, 0x3727c5ac, v51
  v_cvt_pk_bf16_f32 v49, v51, v51
  v_lshlrev_b32 v51, 16, v49
  v_and_b32 v49, 0xffff0000, v49
  v_sqrt_f32 v51, v51
  s_nop 0
  v_cvt_pk_bf16_f32 v49, v51, v51
  v_lshlrev_b32 v51, 16, v49
  v_and_b32 v49, 0xffff0000, v49
  v_rcp_f32 v48, v51
  v_sub_f32 v52, v32, v50
  v_sub_f32 v53, v33, v50
  v_sub_f32 v54, v34, v50
  v_sub_f32 v55, v35, v50
  v_sub_f32 v56, v36, v50
  v_sub_f32 v57, v37, v50
  v_sub_f32 v58, v38, v50
  v_sub_f32 v59, v39, v50
  v_sub_f32 v60, v40, v50
  v_sub_f32 v61, v41, v50
  v_sub_f32 v62, v42, v50
  v_sub_f32 v63, v43, v50
  v_cvt_pk_bf16_f32 v49, v52, v53
  v_lshlrev_b32 v52, 16, v49
  v_and_b32 v53, 0xffff0000, v49
  v_cvt_pk_bf16_f32 v49, v54, v55
  v_lshlrev_b32 v54, 16, v49
  v_and_b32 v55, 0xffff0000, v49
  v_cvt_pk_bf16_f32 v49, v56, v57
  v_lshlrev_b32 v56, 16, v49
  v_and_b32 v57, 0xffff0000, v49
  v_cvt_pk_bf16_f32 v49, v58, v59
  v_lshlrev_b32 v58, 16, v49
  v_and_b32 v59, 0xffff0000, v49
  v_cvt_pk_bf16_f32 v49, v60, v61
  v_lshlrev_b32 v60, 16, v49
  v_and_b32 v61, 0xffff0000, v49
  v_cvt_pk_bf16_f32 v49, v62, v63
  v_lshlrev_b32 v62, 16, v49
  v_and_b32 v63, 0xffff0000, v49
  v_mul_f32 v32, v52, v48
  v_mul_f32 v33, v53, v48
  v_mul_f32 v34, v54, v48
  v_mul_f32 v35, v55, v48
  v_mul_f32 v36, v56, v48
  v_mul_f32 v37, v57, v48
  v_mul_f32 v38, v58, v48
  v_mul_f32 v39, v59, v48
  v_mul_f32 v40, v60, v48
  v_mul_f32 v41, v61, v48
  v_mul_f32 v42, v62, v48
  v_mul_f32 v43, v63, v48
  v_fma_f32 v52, -v32, v51, v52
  v_fma_f32 v53, -v33, v51, v53
  v_fma_f32 v54, -v34, v51, v54
  v_fma_f32 v55, -v35, v51, v55
  v_fma_f32 v56, -v36, v51, v56
  v_fma_f32 v57, -v37, v51, v57
  v_fma_f32 v58, -v38, v51, v58
  v_fma_f32 v59, -v39, v51, v59
  v_fma_f32 v60, -v40, v51, v60
  v_fma_f32 v61, -v41, v51, v61
  v_fma_f32 v62, -v42, v51, v62
  v_fma_f32 v63, -v43, v51, v63
  v_fmac_f32 v32, v52, v48
  v_fmac_f32 v33, v53, v48
  v_fmac_f32 v34, v54, v48
  v_fmac_f32 v35, v55, v48
  v_fmac_f32 v36, v56, v48
  v_fmac_f32 v37, v57, v48
  v_fmac_f32 v38, v58, v48
  v_fmac_f32 v39, v59, v48
  v_fmac_f32 v40, v60, v48
  v_fmac_f32 v41, v61, v48
  v_fmac_f32 v42, v62, v48
  v_fmac_f32 v43, v63, v48
  v_cvt_pk_bf16_f32 v49, v32, v33
  v_lshlrev_b32 v32, 16, v49
  v_and_b32 v33, 0xffff0000, v49
  v_cvt_pk_bf16_f32 v49, v34, v35
  v_lshlrev_b32 v34, 16, v49
  v_and_b32 v35, 0xffff0000, v49
  v_cvt_pk_bf16_f32 v49, v36, v37
  v_lshlrev_b32 v36, 16, v49
  v_and_b32 v37, 0xffff0000, v49
  v_cvt_pk_bf16_f32 v49, v38, v39
  v_lshlrev_b32 v38, 16, v49
  v_and_b32 v39, 0xffff0000, v49
  v_cvt_pk_bf16_f32 v49, v40, v41
  v_lshlrev_b32 v40, 16, v49
  v_and_b32 v41, 0xffff0000, v49
  v_cvt_pk_bf16_f32 v49, v42, v43
  v_lshlrev_b32 v42, 16, v49
  v_and_b32 v43, 0xffff0000, v49
  ds_read_b128 v[48:51], v12 offset:13312
  ds_read_b128 v[52:55], v12 offset:15872
  s_waitcnt lgkmcnt(0)
  v_mul_f32 v52, v52, v32
  v_mul_f32 v53, v53, v33
  v_mul_f32 v54, v54, v34
  v_mul_f32 v55, v55, v35
  v_cvt_pk_bf16_f32 v252, v52, v53
  v_lshlrev_b32 v52, 16, v252
  v_and_b32 v53, 0xffff0000, v252
  v_cvt_pk_bf16_f32 v252, v54, v55
  v_lshlrev_b32 v54, 16, v252
  v_and_b32 v55, 0xffff0000, v252
  v_add_f32 v52, v52, v48
  v_add_f32 v53, v53, v49
  v_add_f32 v54, v54, v50
  v_add_f32 v55, v55, v51
  v_cvt_pk_bf16_f32 v52, v52, v52
  v_cvt_pk_bf16_f32 v53, v53, v53
  v_cvt_pk_bf16_f32 v54, v54, v54
  v_cvt_pk_bf16_f32 v55, v55, v55
  ds_write_b128 v12, v[52:55] offset:5120
  s_waitcnt lgkmcnt(0)
  ds_read_b128 v[48:51], v12 offset:14336
  ds_read_b128 v[52:55], v12 offset:16896
  s_waitcnt lgkmcnt(0)
  v_mul_f32 v52, v52, v36
  v_mul_f32 v53, v53, v37
  v_mul_f32 v54, v54, v38
  v_mul_f32 v55, v55, v39
  v_cvt_pk_bf16_f32 v252, v52, v53
  v_lshlrev_b32 v52, 16, v252
  v_and_b32 v53, 0xffff0000, v252
  v_cvt_pk_bf16_f32 v252, v54, v55
  v_lshlrev_b32 v54, 16, v252
  v_and_b32 v55, 0xffff0000, v252
  v_add_f32 v52, v52, v48
  v_add_f32 v53, v53, v49
  v_add_f32 v54, v54, v50
  v_add_f32 v55, v55, v51
  v_cvt_pk_bf16_f32 v52, v52, v52
  v_cvt_pk_bf16_f32 v53, v53, v53
  v_cvt_pk_bf16_f32 v54, v54, v54
  v_cvt_pk_bf16_f32 v55, v55, v55
  ds_write_b128 v12, v[52:55] offset:6144
  s_waitcnt lgkmcnt(0)
  ds_read_b128 v[48:51], v12 offset:15360
  ds_read_b128 v[52:55], v12 offset:17920
  s_waitcnt lgkmcnt(0)
  v_mul_f32 v52, v52, v40
  v_mul_f32 v53, v53, v41
  v_mul_f32 v54, v54, v42
  v_mul_f32 v55, v55, v43
  v_cvt_pk_bf16_f32 v252, v52, v53
  v_lshlrev_b32 v52, 16, v252
  v_and_b32 v53, 0xffff0000, v252
  v_cvt_pk_bf16_f32 v252, v54, v55
  v_lshlrev_b32 v54, 16, v252
  v_and_b32 v55, 0xffff0000, v252
  v_add_f32 v52, v52, v48
  v_add_f32 v53, v53, v49
  v_add_f32 v54, v54, v50
  v_add_f32 v55, v55, v51
  v_cvt_pk_bf16_f32 v52, v52, v52
  v_cvt_pk_bf16_f32 v53, v53, v53
  v_cvt_pk_bf16_f32 v54, v54, v54
  v_cvt_pk_bf16_f32 v55, v55, v55
  ds_write_b128 v12, v[52:55] offset:7168
  s_waitcnt lgkmcnt(0)
L_t3_wait:
  s_nop 7
  s_waitcnt vmcnt(0)
  s_barrier
  v_lshrrev_b32 v13, 3, v1
  v_mul_u32_u24 v13, 40, v13
  s_mul_i32 s10, s3, 320
  v_add_u32 v13, s10, v13
  ds_read_b64 v[144:145], v13 offset:5120
  ds_read_b64 v[146:147], v13 offset:5128
  ds_read_b64 v[148:149], v13 offset:5136
  ds_read_b64 v[150:151], v13 offset:5144
  ds_read_b64 v[152:153], v13 offset:5152
  v_mov_b32 v156, 0
  v_mov_b32 v157, 0
  v_mov_b32 v158, 0
  v_mov_b32 v159, 0
  s_waitcnt lgkmcnt(0)
  v_and_b32 v244, v144, v4
  v_and_b32 v245, v144, v5
  v_and_b32 v246, v144, v6
  v_and_b32 v247, v144, v7
  s_nop 1
  v_mfma_f32_16x16x32_bf16 v[156:159], v[244:247], v[96:99], v[156:159]
  v_and_b32 v248, v145, v4
  v_and_b32 v249, v145, v5
  v_and_b32 v250, v145, v6
  v_and_b32 v251, v145, v7
  s_nop 1
  v_mfma_f32_16x16x32_bf16 v[156:159], v[248:251], v[100:103], v[156:159]
  v_and_b32 v244, v146, v4
  v_and_b32 v245, v146, v5
  v_and_b32 v246, v146, v6
  v_and_b32 v247, v146, v7
  s_nop 1
  v_mfma_f32_16x16x32_bf16 v[156:159], v[244:247], v[104:107], v[156:159]
  v_and_b32 v248, v147, v4
  v_and_b32 v249, v147, v5
  v_and_b32 v250, v147, v6
  v_and_b32 v251, v147, v7
  s_nop 1
  v_mfma_f32_16x16x32_bf16 v[156:159], v[248:251], v[108:111], v[156:159]
  v_and_b32 v244, v148, v4
  v_and_b32 v245, v148, v5
  v_and_b32 v246, v148, v6
  v_and_b32 v247, v148, v7
  s_nop 1
  v_mfma_f32_16x16x32_bf16 v[156:159], v[244:247], v[112:115], v[156:159]
  v_and_b32 v248, v149, v4
  v_and_b32 v249, v149, v5
  v_and_b32 v250, v149, v6
  v_and_b32 v251, v149, v7
  s_nop 1
  v_mfma_f32_16x16x32_bf16 v[156:159], v[248:251], v[116:119], v[156:159]
  v_and_b32 v244, v150, v4
  v_and_b32 v245, v150, v5
  v_and_b32 v246, v150, v6
  v_and_b32 v247, v150, v7
  s_nop 1
  v_mfma_f32_16x16x32_bf16 v[156:159], v[244:247], v[120:123], v[156:159]
  v_and_b32 v248, v151, v4
  v_and_b32 v249, v151, v5
  v_and_b32 v250, v151, v6
  v_and_b32 v251, v151, v7
  s_nop 1
  v_mfma_f32_16x16x32_bf16 v[156:159], v[248:251], v[124:127], v[156:159]
  v_and_b32 v244, v152, v4
  v_and_b32 v245, v152, v5
  v_and_b32 v246, v152, v6
  v_and_b32 v247, v152, v7
  s_nop 1
  v_mfma_f32_16x16x32_bf16 v[156:159], v[244:247], v[128:131], v[156:159]
  v_and_b32 v248, v153, v4
  v_and_b32 v249, v153, v5
  v_and_b32 v250, v153, v6
  v_and_b32 v251, v153, v7
  s_nop 1
  v_mfma_f32_16x16x32_bf16 v[156:159], v[248:251], v[132:135], v[156:159]
  v_lshrrev_b32 v13, 5, v1
  v_bfe_u32 v15, v1, 3, 1
  v_cmp_eq_u32 vcc, v13, v15
  v_lshlrev_b32 v13, 8, v13
  v_and_b32 v15, 7, v1
  v_lshl_add_u32 v13, v15, 5, v13
  v_bfe_u32 v15, v1, 4, 1
  v_lshl_add_u32 v13, v15, 4, v13
  s_lshl_b32 s10, s3, 9
  s_add_u32 s10, s10, 45056
  v_add_u32 v13, s10, v13
  v_mov_b32 v15, 8704
  v_cndmask_b32 v13, v15, v13, vcc
  ds_write_b128 v13, v[156:159]
  s_waitcnt lgkmcnt(0)
  s_barrier
  s_lshl_b32 s10, s3, 5
  v_lshlrev_b32 v13, 3, v11
  v_add_u32 v13, s10, v13
  ds_read_b64 v[144:145], v13 offset:45056
  ds_read_b64 v[146:147], v13 offset:45312
  ds_read_b64 v[148:149], v13 offset:45568
  ds_read_b64 v[150:151], v13 offset:45824
  ds_read_b64 v[152:153], v13 offset:46080
  ds_read_b64 v[154:155], v13 offset:46336
  ds_read_b64 v[156:157], v13 offset:46592
  ds_read_b64 v[158:159], v13 offset:46848
  ds_read_b64 v[160:161], v13 offset:47104
  ds_read_b64 v[162:163], v13 offset:47360
  ds_read_b64 v[164:165], v13 offset:47616
  ds_read_b64 v[166:167], v13 offset:47872
  ds_read_b64 v[168:169], v13 offset:48128
  ds_read_b64 v[170:171], v13 offset:48384
  ds_read_b64 v[172:173], v13 offset:48640
  ds_read_b64 v[174:175], v13 offset:48896
  s_waitcnt lgkmcnt(0)
  v_add_f32 v144, v144, v146
  v_add_f32 v145, v145, v147
  v_add_f32 v144, v144, v148
  v_add_f32 v145, v145, v149
  v_add_f32 v144, v144, v150
  v_add_f32 v145, v145, v151
  v_add_f32 v144, v144, v152
  v_add_f32 v145, v145, v153
  v_add_f32 v144, v144, v154
  v_add_f32 v145, v145, v155
  v_add_f32 v144, v144, v156
  v_add_f32 v145, v145, v157
  v_add_f32 v144, v144, v158
  v_add_f32 v145, v145, v159
  v_add_f32 v144, v144, v160
  v_add_f32 v145, v145, v161
  v_add_f32 v144, v144, v162
  v_add_f32 v145, v145, v163
  v_add_f32 v144, v144, v164
  v_add_f32 v145, v145, v165
  v_add_f32 v144, v144, v166
  v_add_f32 v145, v145, v167
  v_add_f32 v144, v144, v168
  v_add_f32 v145, v145, v169
  v_add_f32 v144, v144, v170
  v_add_f32 v145, v145, v171
  v_add_f32 v144, v144, v172
  v_add_f32 v145, v145, v173
  v_add_f32 v144, v144, v174
  v_add_f32 v145, v145, v175
  v_cvt_pk_bf16_f32 v252, v144, v145
  v_lshlrev_b32 v144, 16, v252
  v_and_b32 v145, 0xffff0000, v252
  v_mul_f32 v244, 0xbfb8aa3b, v144
  v_mul_f32 v245, 0xbfb8aa3b, v145
  v_exp_f32 v244, v244
  v_exp_f32 v245, v245
  v_add_f32 v244, 1.0, v244
  v_add_f32 v245, 1.0, v245
  v_rcp_f32 v244, v244
  v_rcp_f32 v245, v245
  v_mul_f32 v144, v144, v244
  v_mul_f32 v145, v145, v245
  v_cvt_pk_bf16_f32 v144, v144, v144
  v_cvt_pk_bf16_f32 v145, v145, v145
  v_mov_b32 v152, 0
  v_mov_b32 v153, 0
  v_mov_b32 v154, 0
  v_mov_b32 v155, 0
  v_mov_b32 v156, 0
  v_mov_b32 v157, 0
  v_mov_b32 v158, 0
  v_mov_b32 v159, 0
  v_mov_b32 v160, 0
  v_mov_b32 v161, 0
  v_mov_b32 v162, 0
  v_mov_b32 v163, 0
  v_mov_b32 v164, 0
  v_mov_b32 v165, 0
  v_mov_b32 v166, 0
  v_mov_b32 v167, 0
  v_mov_b32 v168, 0
  v_mov_b32 v169, 0
  v_mov_b32 v170, 0
  v_mov_b32 v171, 0
  v_and_b32 v244, v144, v4
  v_and_b32 v245, v144, v5
  v_and_b32 v246, v144, v6
  v_and_b32 v247, v144, v7
  s_nop 1
  v_mfma_f32_16x16x32_bf16 v[152:155], v[244:247], v[136:139], v[152:155]
  v_and_b32 v248, v144, v4
  v_and_b32 v249, v144, v5
  v_and_b32 v250, v144, v6
  v_and_b32 v251, v144, v7
  s_nop 1
  v_mfma_f32_16x16x32_bf16 v[156:159], v[248:251], v[140:143], v[156:159]
  v_and_b32 v244, v144, v4
  v_and_b32 v245, v144, v5
  v_and_b32 v246, v144, v6
  v_and_b32 v247, v144, v7
  s_nop 1
  v_mfma_f32_16x16x32_bf16 v[160:163], v[244:247], v[176:179], v[160:163]
  v_and_b32 v248, v144, v4
  v_and_b32 v249, v144, v5
  v_and_b32 v250, v144, v6
  v_and_b32 v251, v144, v7
  s_nop 1
  v_mfma_f32_16x16x32_bf16 v[164:167], v[248:251], v[180:183], v[164:167]
  v_and_b32 v244, v144, v4
  v_and_b32 v245, v144, v5
  v_and_b32 v246, v144, v6
  v_and_b32 v247, v144, v7
  s_nop 1
  v_mfma_f32_16x16x32_bf16 v[168:171], v[244:247], v[184:187], v[168:171]
  v_and_b32 v248, v145, v4
  v_and_b32 v249, v145, v5
  v_and_b32 v250, v145, v6
  v_and_b32 v251, v145, v7
  s_nop 1
  v_mfma_f32_16x16x32_bf16 v[152:155], v[248:251], v[188:191], v[152:155]
  v_and_b32 v244, v145, v4
  v_and_b32 v245, v145, v5
  v_and_b32 v246, v145, v6
  v_and_b32 v247, v145, v7
  s_nop 1
  v_mfma_f32_16x16x32_bf16 v[156:159], v[244:247], v[192:195], v[156:159]
  v_and_b32 v248, v145, v4
  v_and_b32 v249, v145, v5
  v_and_b32 v250, v145, v6
  v_and_b32 v251, v145, v7
  s_nop 1
  v_mfma_f32_16x16x32_bf16 v[160:163], v[248:251], v[196:199], v[160:163]
  v_and_b32 v244, v145, v4
  v_and_b32 v245, v145, v5
  v_and_b32 v246, v145, v6
  v_and_b32 v247, v145, v7
  s_nop 1
  v_mfma_f32_16x16x32_bf16 v[164:167], v[244:247], v[200:203], v[164:167]
  v_and_b32 v248, v145, v4
  v_and_b32 v249, v145, v5
  v_and_b32 v250, v145, v6
  v_and_b32 v251, v145, v7
  s_nop 1
  v_mfma_f32_16x16x32_bf16 v[168:171], v[248:251], v[204:207], v[168:171]
  s_mul_i32 s10, s3, 2560
  v_add_u32 v13, s10, v14
  s_mov_b32 exec_lo, -1
  s_mov_b32 exec_hi, 0
  ds_write_b128 v13, v[152:155] offset:24576
  ds_write_b128 v13, v[156:159] offset:25088
  ds_write_b128 v13, v[160:163] offset:25600
  ds_write_b128 v13, v[164:167] offset:26112
  ds_write_b128 v13, v[168:171] offset:26624
  s_mov_b32 exec_lo, -1
  s_mov_b32 exec_hi, -1
  s_waitcnt lgkmcnt(0)
  s_barrier
  s_cmp_ge_u32 s3, 3
  s_cbranch_scc1 L_t3a
  v_lshlrev_b32 v13, 4, v0
  ds_read_b128 v[144:147], v13 offset:24576
  ds_read_b128 v[148:151], v13 offset:27136
  ds_read_b128 v[152:155], v13 offset:29696
  ds_read_b128 v[156:159], v13 offset:32256
  ds_read_b128 v[160:163], v13 offset:34816
  ds_read_b128 v[164:167], v13 offset:37376
  ds_read_b128 v[168:171], v13 offset:39936
  ds_read_b128 v[172:175], v13 offset:42496
  s_waitcnt lgkmcnt(0)
  v_add_f32 v144, v144, v148
  v_add_f32 v145, v145, v149
  v_add_f32 v146, v146, v150
  v_add_f32 v147, v147, v151
  v_add_f32 v144, v144, v152
  v_add_f32 v145, v145, v153
  v_add_f32 v146, v146, v154
  v_add_f32 v147, v147, v155
  v_add_f32 v144, v144, v156
  v_add_f32 v145, v145, v157
  v_add_f32 v146, v146, v158
  v_add_f32 v147, v147, v159
  v_add_f32 v144, v144, v160
  v_add_f32 v145, v145, v161
  v_add_f32 v146, v146, v162
  v_add_f32 v147, v147, v163
  v_add_f32 v144, v144, v164
  v_add_f32 v145, v145, v165
  v_add_f32 v146, v146, v166
  v_add_f32 v147, v147, v167
  v_add_f32 v144, v144, v168
  v_add_f32 v145, v145, v169
  v_add_f32 v146, v146, v170
  v_add_f32 v147, v147, v171
  v_add_f32 v144, v144, v172
  v_add_f32 v145, v145, v173
  v_add_f32 v146, v146, v174
  v_add_f32 v147, v147, v175
  v_min_u32 v144, 0xfffffffe, v144
  v_min_u32 v145, 0xfffffffe, v145
  v_min_u32 v146, 0xfffffffe, v146
  v_min_u32 v147, 0xfffffffe, v147
  v_lshrrev_b32 v13, 3, v0
  v_lshlrev_b32 v13, 12, v13
  v_and_b32 v15, 7, v0
  v_lshl_add_u32 v13, v15, 4, v13
  v_mov_b32 v15, 0x7fffffff
  v_cmp_gt_u32 vcc, 160, v0
  s_nop 1
  v_cndmask_b32 v13, v15, v13, vcc
  buffer_store_dwordx4 v[144:147], v13, s[60:63], s42 offen sc1
L_t3a:
  s_nop 7
  s_cmp_lg_u32 s3, 0
  s_cbranch_scc1 L_end
  s_cmp_ge_u32 s5, 20
  s_cbranch_scc1 L_end
  s_mul_i32 s10, s4, 20
  s_add_u32 s10, s10, s5
  s_lshl_b32 s10, s10, 12
  s_add_u32 s10, s10, 1212416
  v_lshlrev_b32 v13, 4, v1
  v_mov_b32 v15, 0x7fffffff
  v_add_u32 v12, 3072, v13
  v_cmp_gt_u32 vcc, 24, v1
  s_nop 1
  v_cndmask_b32 v12, v15, v12, vcc
  s_mov_b32 s95, 0
L_g3:
  s_nop 7
  buffer_load_dwordx4 v[16:19], v13, s[60:63], s10 offen offset:0 sc1
  buffer_load_dwordx4 v[20:23], v13, s[60:63], s10 offen offset:1024 sc1
  buffer_load_dwordx4 v[24:27], v13, s[60:63], s10 offen offset:2048 sc1
  buffer_load_dwordx4 v[28:31], v12, s[60:63], s10 offen sc1
  s_waitcnt vmcnt(0)
  v_max3_u32 v252, v16, v17, v18
  v_max3_u32 v252, v252, v19, v20
  v_max3_u32 v252, v252, v21, v22
  v_max3_u32 v252, v252, v23, v24
  v_max3_u32 v252, v252, v25, v26
  v_max3_u32 v252, v252, v27, v28
  v_max3_u32 v252, v252, v29, v30
  v_max_u32 v252, v252, v31
  v_cmp_eq_u32 vcc, -1, v252
  s_cbranch_vccz L_g3_done
  s_add_u32 s95, s95, 1
  s_cmp_lt_u32 s95, 200000
  s_cbranch_scc1 L_g3
L_g3_done:
  s_nop 7
  v_add_f32 v16, v16, v20
  v_add_f32 v24, v24, v28
  v_add_f32 v16, v16, v24
  v_add_f32 v17, v17, v21
  v_add_f32 v25, v25, v29
  v_add_f32 v17, v17, v25
  v_add_f32 v18, v18, v22
  v_add_f32 v26, v26, v30
  v_add_f32 v18, v18, v26
  v_add_f32 v19, v19, v23
  v_add_f32 v27, v27, v31
  v_add_f32 v19, v19, v27
  v_add_f32_dpp v16, v16, v16 row_ror:8 row_mask:0xf bank_mask:0xf
  v_add_f32_dpp v17, v17, v17 row_ror:8 row_mask:0xf bank_mask:0xf
  v_add_f32_dpp v18, v18, v18 row_ror:8 row_mask:0xf bank_mask:0xf
  v_add_f32_dpp v19, v19, v19 row_ror:8 row_mask:0xf bank_mask:0xf
  v_mov_b32 v252, v16
  v_mov_b32 v253, v17
  v_mov_b32 v254, v18
  v_mov_b32 v255, v19
  v_permlane16_swap_b32 v16, v252
  v_permlane16_swap_b32 v17, v253
  v_permlane16_swap_b32 v18, v254
  v_permlane16_swap_b32 v19, v255
  v_add_f32 v16, v16, v252
  v_add_f32 v17, v17, v253
  v_add_f32 v18, v18, v254
  v_add_f32 v19, v19, v255
  v_mov_b32 v252, v16
  v_mov_b32 v253, v17
  v_mov_b32 v254, v18
  v_mov_b32 v255, v19
  v_permlane32_swap_b32 v16, v252
  v_permlane32_swap_b32 v17, v253
  v_permlane32_swap_b32 v18, v254
  v_permlane32_swap_b32 v19, v255
  v_add_f32 v16, v16, v252
  v_add_f32 v17, v17, v253
  v_add_f32 v18, v18, v254
  v_add_f32 v19, v19, v255
  v_cvt_pk_bf16_f32 v252, v16, v17
  v_lshlrev_b32 v16, 16, v252
  v_and_b32 v17, 0xffff0000, v252
  v_cvt_pk_bf16_f32 v252, v18, v19
  v_lshlrev_b32 v18, 16, v252
  v_and_b32 v19, 0xffff0000, v252
  v_mul_f32 v16, v16, v212
  v_mul_f32 v17, v17, v213
  v_mul_f32 v18, v18, v214
  v_mul_f32 v19, v19, v215
  v_cvt_pk_bf16_f32 v252, v16, v17
  v_lshlrev_b32 v16, 16, v252
  v_and_b32 v17, 0xffff0000, v252
  v_cvt_pk_bf16_f32 v252, v18, v19
  v_lshlrev_b32 v18, 16, v252
  v_and_b32 v19, 0xffff0000, v252
  v_add_f32 v16, v16, v216
  v_add_f32 v17, v17, v217
  v_add_f32 v18, v18, v218
  v_add_f32 v19, v19, v219
  v_cvt_pk_bf16_f32 v16, v16, v17
  v_cvt_pk_bf16_f32 v17, v18, v19
  v_lshlrev_b32 v13, 3, v1
  s_mul_i32 s10, s4, 1280
  s_lshl_b32 s11, s5, 6
  s_add_u32 s10, s10, s11
  s_mov_b32 exec_lo, 0xff
  s_mov_b32 exec_hi, 0
  buffer_store_dwordx2 v[16:17], v13, s[88:91], s10 offen
  s_mov_b32 exec_lo, -1
  s_mov_b32 exec_hi, -1
L_end:
  s_nop 7
  s_endpgm
L_codeend:

.section .rodata,"a"
.p2align 6
.amdhsa_kernel adaLN_cond__mha_block_cached__dense_activation_silu__decode_kernel
  .amdhsa_next_free_vgpr 256
  .amdhsa_next_free_sgpr 102
  .amdhsa_accum_offset 256
  .amdhsa_group_segment_fixed_size 0
  .amdhsa_kernarg_size 104
  .amdhsa_user_sgpr_count 2
  .amdhsa_user_sgpr_kernarg_segment_ptr 1
  .amdhsa_system_sgpr_workgroup_id_x 1
.end_amdhsa_kernel
```
